```python
import torch

def _softmax(x, axis=-1):
    return torch.softmax(x, dim=axis)
def _gelu(x):
    return torch.nn.functional.gelu(x, approximate="tanh")
def _silu(x):
    return torch.nn.functional.silu(x)
def _sigmoid(x):
    return torch.sigmoid(x)
def _layernorm(x, axis=-1, eps=1e-5):
    m = x.mean(dim=axis, keepdim=True)
    v = x.var(dim=axis, keepdim=True, unbiased=False)
    return (x - m) / torch.sqrt(v + eps)
def _scatter_add(tgt, idx, src, axis=0):
    return tgt.clone().index_add_(axis, idx, src)
def _segment_sum(src, seg, n):
    out = torch.zeros((n,) + src.shape[1:], dtype=src.dtype)
    return out.index_add_(0, seg, src)
def _pad(x, pw):
    flat = tuple(v for pair in reversed(pw) for v in pair)
    return torch.nn.functional.pad(x, flat)

kernel_name = 'sequential_preLN__ssm_conv_h3__geglu_ffn__prompt'

def setup_inputs():

    _w = (lambda a: (lambda t: t.to(torch.bfloat16) if t.is_floating_point() else t)(torch.as_tensor(a)))
    def _A_setup():
        B, S, D = 1, 2048, 640
        ks = 4
        return {
            "q": _w((lambda *s: torch.randn(*s, dtype=torch.bfloat16) * 0.05)(B, S, D)),
            "k": _w((lambda *s: torch.randn(*s, dtype=torch.bfloat16) * 0.4)(B, S, D)),
            "v": _w((lambda *s: torch.randn(*s, dtype=torch.bfloat16) * 0.4)(B, S, D)),
            "shift_k": _w((lambda *s: torch.randn(*s, dtype=torch.bfloat16) * 0.4)(D, ks) * 0.5),
            "ssm_k": _w((lambda *s: torch.randn(*s, dtype=torch.bfloat16) * 0.4)(D, S) * (1.0 / S ** 0.5)),
            "ssm_D": _w((lambda *s: torch.randn(*s, dtype=torch.bfloat16) * 0.4)(D)),
        }
    _A_in = _A_setup()

    def _B_setup():
        B, S, D, F = 1, 2048, 640, 1536
        return {
            "x": _w((lambda *s: torch.randn(*s, dtype=torch.bfloat16) * 0.05)(B, S, D)),
            "w_gate": _w((lambda *s: torch.randn(*s, dtype=torch.bfloat16) * 0.05)(D, F)),
            "w_up": _w((lambda *s: torch.randn(*s, dtype=torch.bfloat16) * 0.05)(D, F)),
            "w_down": _w((lambda *s: torch.randn(*s, dtype=torch.bfloat16) * 0.05)(F, D)),
        }
    _B_in = _B_setup()

    return {
        "A_q": _A_in["q"],
        "A_k": _A_in["k"],
        "A_v": _A_in["v"],
        "A_shift_k": _A_in["shift_k"],
        "A_ssm_k": _A_in["ssm_k"],
        "A_ssm_D": _A_in["ssm_D"],
        "B_x": _B_in["x"],
        "B_w_gate": _B_in["w_gate"],
        "B_w_up": _B_in["w_up"],
        "B_w_down": _B_in["w_down"],
    }

def reference(A_q, A_k, A_v, A_shift_k, A_ssm_k, A_ssm_D, B_x, B_w_gate, B_w_up, B_w_down):
    def _A_ref(q, k, v, shift_k, ssm_k, ssm_D):
        B, S, D = q.shape
        ks = shift_k.shape[-1]
        k_pad = _pad(k, ((0, 0), (ks - 1, 0), (0, 0)))
        k_shift = torch.zeros_like(k)
        for t in range(ks):
            k_shift = k_shift + k_pad[:, t:t + S, :] * shift_k[:, ks - 1 - t][None, None, :]
        kv = k_shift * v
        L = 2 * S
        kv_pad = _pad(kv, ((0, 0), (0, S), (0, 0)))
        kf_pad = _pad(ssm_k, ((0, 0), (0, S)))
        kv_f = (lambda x, axes=(-2,-1): torch.fft.rfft2(x.float(), dim=axes))(kv_pad[:, None, :, :], axes=(1, 2))
        kf_f = (lambda x, axes=(-2,-1): torch.fft.rfft2(x.float(), dim=axes))(kf_pad[:, None, :], axes=(1, 2))
        kf_f = (lambda x, *d: x.permute(*d))(kf_f, 1, 2, 0)
        y_f = kv_f * kf_f[None, :, :, :]
        y = (lambda x, s, axes=(-2,-1): torch.fft.irfft2(x, s=s, dim=axes).to(torch.bfloat16))(y_f, (1, L), axes=(1, 2))[:, 0, :S, :]
        y = y + kv * ssm_D[None, None, :]
        return q * y

    def _B_ref(x, w_gate, w_up, w_down):
        return (_gelu(x @ w_gate) * (x @ w_up)) @ w_down

    x = A_q
    h = x + _A_ref(_layernorm(x, axis=-1), A_k, A_v, A_shift_k, A_ssm_k, A_ssm_D)
    h2 = h + _B_ref(_layernorm(h, axis=-1), B_w_gate, B_w_up, B_w_down)
    return h2
```

```asm
; @launch grid=(256,1,1) block=(256,1,1) lds=163840
.amdgcn_target "amdgcn-amd-amdhsa--gfx950"
.text
.globl sequential_preLN__ssm_conv_h3__geglu_ffn__prompt_kernel
.p2align 8
.type sequential_preLN__ssm_conv_h3__geglu_ffn__prompt_kernel,@function
sequential_preLN__ssm_conv_h3__geglu_ffn__prompt_kernel:
    s_cmp_ge_u32 s2, 0x100
    s_nop 0
    s_cbranch_scc1 .Lend
    s_load_dwordx2 s[4:5], s[0:1], 8
    s_load_dwordx2 s[44:45], s[0:1], 96
    s_load_dwordx2 s[8:9], s[0:1], 16
    s_load_dwordx2 s[12:13], s[0:1], 24
    s_load_dwordx2 s[16:17], s[0:1], 32
    s_load_dwordx2 s[20:21], s[0:1], 0
    s_load_dwordx2 s[24:25], s[0:1], 56
    s_load_dwordx2 s[28:29], s[0:1], 64
    s_load_dwordx2 s[32:33], s[0:1], 72
    s_load_dwordx2 s[36:37], s[0:1], 80
    s_load_dwordx2 s[40:41], s[0:1], 88
    s_load_dwordx2 s[48:49], s[0:1], 40
    v_lshrrev_b32 v1, 6, v0
    s_and_b32 s50, s2, 7
    s_lshr_b32 s51, s2, 3
    v_readfirstlane_b32 s3, v1
    v_mov_b32 v1, v0
    v_and_b32 v0, 63, v0
    s_mov_b32 s6, 2621440
    s_mov_b32 s7, 0x20000
    s_mov_b32 s10, 2621440
    s_mov_b32 s11, 0x20000
    s_mov_b32 s14, 5120
    s_mov_b32 s15, 0x20000
    s_mov_b32 s18, 4096
    s_mov_b32 s19, 0x20000
    s_mov_b32 s22, 2621440
    s_mov_b32 s23, 0x20000
    s_mov_b32 s26, 1966080
    s_mov_b32 s27, 0x20000
    s_mov_b32 s30, 1966080
    s_mov_b32 s31, 0x20000
    s_mov_b32 s34, 1966080
    s_mov_b32 s35, 0x20000
    s_mov_b32 s38, 2621440
    s_mov_b32 s39, 0x20000
    s_mov_b32 s42, 256
    s_mov_b32 s43, 0x20000
    s_mov_b32 s46, 41943040
    s_mov_b32 s47, 0x20000
    s_and_b32 s53, s51, 15
    s_mov_b32 s52, s50
    s_cmp_lt_u32 s51, 16
    s_cbranch_scc1 .Lconv
    s_lshr_b32 s52, s50, 2
    s_add_u32 s52, s52, 8
    s_and_b32 s60, s50, 3
    s_lshl2_add_u32 s53, s60, s53
    s_cmp_lt_u32 s51, 20
    s_cbranch_scc1 .Lconv
    s_cmp_lg_u32 s2, 210
    s_cbranch_scc1 .Lnoinit
    v_lshrrev_b32 v2, 3, v1
    v_and_b32 v3, 7, v0
    v_lshlrev_b32 v3, 4, v3
    v_lshl_add_u32 v2, v2, 8, v3
    v_mov_b32 v4, 0
    v_mov_b32 v5, 0
    v_mov_b32_e64 v6, 0
    v_mov_b32 v7, 0
    s_waitcnt lgkmcnt(0)
    buffer_store_dwordx4 v[4:7], v2, s[44:47], 0 offen sc1
    s_mov_b32 s60, 8192
    buffer_store_dwordx4 v[4:7], v2, s[44:47], s60 offen sc1
    s_mov_b32 s60, 2097152
    buffer_store_dwordx4 v[4:7], v2, s[44:47], s60 offen sc1
    s_mov_b32 s60, 2105344
    buffer_store_dwordx4 v[4:7], v2, s[44:47], s60 offen sc1
    v_mov_b32 v3, 1
    s_waitcnt vmcnt(0)
    s_barrier
    s_cmp_lg_u32 s3, 0
    s_cbranch_scc1 .Lside
    s_mov_b64 exec, 1
    buffer_store_dword v3, off, s[40:43], 0 sc1
    s_mov_b64 exec, -1
    s_branch .Lside
.Lnoinit:
    s_cmp_lg_u32 s2, 218
    s_cbranch_scc1 .Lnopol
    s_and_b32 s61, s3, 1
    s_lshl_b32 s60, s61, 13
    s_lshl_b32 s62, s3, 8
    s_add_u32 s60, s60, s62
    s_add_u32 s60, s60, 32768
    s_add_u32 s61, s61, 1
    v_mov_b32 v4, s61
    v_mov_b32 v5, 0
    v_lshlrev_b32 v2, 2, v0
    s_waitcnt lgkmcnt(0)
    buffer_store_dword v5, v2, s[44:47], s60 offen sc1
    s_waitcnt vmcnt(0)
    s_mov_b64 exec, 1
    s_barrier
    s_mov_b32 s63, 0
    s_atomic_add s63, s[44:45], s60 glc
    s_waitcnt lgkmcnt(0)
    buffer_atomic_cmpswap v[4:5], off, s[40:43], 0 offset:128 sc1
    s_mov_b64 exec, -1
    s_branch .Lside
.Lnopol:
    s_getpc_b64 s[60:61]
.Lpc:
    s_and_b32 s62, s51, 3
    s_lshl2_add_u32 s62, s62, s3
    s_mul_i32 s62, s62, 2304
    v_min_u32_e64 v2, 17, v0
    v_lshl_add_u32 v2, v2, 7, s62
    v_min_u32 v2, .Lcode_end-.Lpc-4, v2
    v_mov_b32_e64 v3, 0
    v_lshl_add_u64 v[4:5], v[2:3], 0, s[60:61]
    global_load_dword a253, v[4:5], off
    s_branch .Lside
.Lconv:
    s_lshl4_add_u32 s54, s52, s53
    v_and_b32 v3, 15, v0
    v_lshrrev_b32 v4, 4, v0
    s_lshl2_add_u32 s60, s53, s3
    s_mul_i32 s60, s60, 40960
    s_lshl_b32 s61, s52, 7
    s_add_u32 s60, s60, s61
    s_movk_i32 s62, 10240
    v_lshl_add_u32 v1, v3, 3, s60
    v_mad_u32_u24 v1, v4, s62, v1
    v_subrev_u32 v2, 3840, v1
    s_lshl_b32 s61, s52, 9
    v_lshl_add_u32 v5, v3, 5, s61
    s_movk_i32 s63, 5120
    v_lshlrev_b32 v6, 4, v0
    s_waitcnt lgkmcnt(0)
    buffer_load_dwordx4 v[8:11], v5, s[12:15], 0 offen
    buffer_load_dwordx4 v[12:15], v5, s[12:15], 0 offen offset:16
    buffer_load_dwordx2 v[16:17], v2, s[4:7], 0 offen offset:0
    buffer_load_dwordx2 v[18:19], v2, s[4:7], 0 offen offset:1280
    buffer_load_dwordx2 v[20:21], v2, s[4:7], 0 offen offset:2560
    buffer_load_dwordx2 v[22:23], v1, s[4:7], 0 offen offset:0
    buffer_load_dwordx2 v[38:39], v1, s[8:11], 0 offen offset:0 nt
    buffer_load_dwordx2 v[24:25], v1, s[4:7], 0 offen offset:1280
    buffer_load_dwordx2 v[40:41], v1, s[8:11], 0 offen offset:1280 nt
    buffer_load_dwordx2 v[26:27], v1, s[4:7], 0 offen offset:2560
    buffer_load_dwordx2 v[42:43], v1, s[8:11], 0 offen offset:2560 nt
    buffer_load_dwordx2 v[28:29], v1, s[4:7], 0 offen offset:3840
    buffer_load_dwordx2 v[44:45], v1, s[8:11], 0 offen offset:3840 nt
    buffer_load_dwordx2 v[30:31], v1, s[4:7], s63 offen offset:0
    buffer_load_dwordx2 v[46:47], v1, s[8:11], s63 offen offset:0 nt
    buffer_load_dwordx2 v[32:33], v1, s[4:7], s63 offen offset:1280
    buffer_load_dwordx2 v[48:49], v1, s[8:11], s63 offen offset:1280 nt
    buffer_load_dwordx2 v[34:35], v1, s[4:7], s63 offen offset:2560
    buffer_load_dwordx2 v[50:51], v1, s[8:11], s63 offen offset:2560 nt
    buffer_load_dwordx2 v[36:37], v1, s[4:7], s63 offen offset:3840
    buffer_load_dwordx2 v[52:53], v1, s[8:11], s63 offen offset:3840 nt
    v_subrev_u32 v247, 8, v6
    s_mul_i32 s60, s3, 40960
    s_add_u32 s60, s60, 33024
    s_movk_i32 s61, 272
    v_lshl_add_u32 v232, v4, 4, s60
    v_mad_u32_u24 v232, v3, s61, v232
    v_lshl_add_u32 v233, v3, 4, s60
    v_mad_u32_u24 v233, v4, s61, v233
    v_add_u32_e64 v241, s60, v6
    s_add_u32 s60, s60, 32
    v_lshl_add_u32 v236, v3, 5, s60
    v_lshl_add_u32 v236, v4, 4, v236
    s_and_b32 s60, s52, 3
    s_lshl_b32 s60, s60, 19
    s_cmp_lt_u32 s52, 8
    s_cselect_b32 s64, s60, 4194304
    s_lshr_b32 s60, s50, 2
    s_lshl_b32 s60, s60, 13
    s_add_u32 s64, s64, s60
    s_and_b32 s60, s53, 8
    s_add_u32 s60, s60, s53
    s_lshl2_add_u32 s61, s60, s3
    s_lshl_b32 s61, s61, 8
    s_add_u32 s60, s64, s61
    s_mov_b32 s61, 32768
    v_lshl_add_u32 v234, v3, 4, s60
    v_mad_u32_u24 v234, v4, s61, v234
    s_lshr_b32 s60, s50, 2
    s_lshl_b32 s60, s60, 5
    s_and_b32 s1, s50, 3
    s_add_u32 s1, s1, s60
    s_lshl_b32 s1, s1, 8
    s_lshr_b32 s55, s50, 2
    s_lshr_b32 s60, s51, 2
    s_lshl3_add_u32 s55, s55, s60
    s_and_b32 s59, s50, 3
    s_and_b32 s60, s51, 3
    s_lshl2_add_u32 s56, s59, s60
    s_and_b32 s60, s56, 1
    s_mul_i32 s57, s56, 6
    s_add_u32 s58, s57, 4
    s_lshl1_add_u32 s57, s60, s57
    s_lshl_b32 s61, s60, 2
    s_sub_u32 s58, s58, s61
    s_lshr_b32 s61, s57, 2
    s_sub_u32 s60, s61, 3
    s_cmp_lt_u32 s60, 2
    s_cselect_b32 s60, 7, 0
    s_xor_b32 s61, s61, s60
    s_sub_u32 s60, s61, 10
    s_cmp_lt_u32 s60, 2
    s_cselect_b32 s60, 1, 0
    s_xor_b32 s61, s61, s60
    s_lshl_b32 s61, s61, 7
    v_and_b32 v250, 7, v0
    v_lshl_add_u32 v253, v250, 4, s61
    s_lshr_b32 s60, s3, 1
    s_lshl_b32 s60, s60, 6
    s_mul_i32 s68, s59, 160
    s_nop 0
    s_add_u32 s68, s68, s60
    s_mul_i32 s60, s56, 81920
    s_add_u32 s60, s60, 393216
    v_lshl_add_u32 v252, v0, 4, s60
    s_mul_i32 s69, s59, 10
    s_add_u32 s69, s69, s3
    s_lshl_b32 s69, s69, 10
    v_mov_b32 v248, 1
    s_and_b32 s60, s55, 7
    s_lshr_b32 s61, s3, 1
    s_lshl1_add_u32 s60, s60, s61
    s_lshr_b32 s61, s55, 3
    s_lshl1_add_u32 s60, s60, s61
    s_and_b32 s61, s3, 1
    s_lshl1_add_u32 s60, s60, s61
    s_lshl_b32 s60, s60, 12
    v_and_b32_e64 v250, 31, v0
    v_lshl_add_u32 v251, v250, 3, s60
    v_lshrrev_b32_e64 v250, 5, v0
    v_lshl_add_u32 v251, v250, 11, v251
    s_mul_i32 s65, s3, 40960
    s_add_u32 s65, s65, 16384
    v_add_u32_e64 v235, s65, v6
    v_bfe_u32 v237, v0, 2, 2
    v_sub_u32_e64 v237, v237, v4
    v_sub_u32 v237, v237, v4
    s_add_u32 s60, s65, 56
    v_lshl_add_u32 v237, v237, 3, s60
    v_and_b32 v242, 3, v0
    s_movk_i32 s61, 4128
    v_mad_u32_u24 v237, v242, s61, v237
    v_add_u32 v239, 0x800, v237
    v_and_b32 v243, 16, v0
    v_add_u32 v243, s65, v243
    v_mad_u32_u24 v243, v242, s61, v243
    v_and_b32 v242, 7, v0
    s_lshl_b32 s66, s53, 15
    s_add_u32 s66, s66, s64
    s_lshl_b32 s61, s3, 6
    s_add_u32 s60, s66, s61
    v_and_b32 v240, 3, v0
    v_lshl_add_u32 v240, v240, 4, s60
    v_lshrrev_b32_e64 v244, 2, v0
    v_lshl_add_u32 v240, v244, 8, v240
    s_lshl_b32 s60, s3, 12
    v_add_u32 v244, s60, v6
    s_lshl_b32 s61, s54, 14
    s_add_u32 s60, s60, s61
    s_mov_b32 s61, 16777216
    s_cmp_lt_u32 s54, 120
    s_cselect_b32 s61, s61, 7471104
    s_add_u32 s60, s60, s61
    v_add_u32 v245, s60, v6
    s_lshl_b32 s60, s3, 11
    s_add_u32 s60, s60, 32768
    v_add_u32 v238, s60, v6
    v_mov_b32 v224, 0
    v_mov_b32 v225, 0
    v_mov_b32 v226, 0
    v_mov_b32 v227, 0
    s_lshl2_add_u32 s60, s54, s3
    s_lshl_b32 s61, s60, 12
    s_add_u32 s16, s16, s61
    s_addc_u32 s17, s17, 0
    s_lshl_b32 s60, s60, 1
    s_and_b32 s60, s60, -4
    s_load_dword s71, s[48:49], s60
    buffer_load_dwordx4 v[140:143], v6, s[16:19], 0 offen offset:0 nt
    buffer_load_dwordx2 v[138:139], v247, s[16:19], 0 offen
    buffer_load_dwordx4 v[148:151], v6, s[16:19], 0 offen offset:1024 nt
    buffer_load_dwordx2 v[146:147], v6, s[16:19], 0 offen offset:1016
    buffer_load_dwordx4 v[156:159], v6, s[16:19], 0 offen offset:2048 nt
    buffer_load_dwordx2 v[154:155], v6, s[16:19], 0 offen offset:2040
    buffer_load_dwordx4 v[164:167], v6, s[16:19], 0 offen offset:3072 nt
    buffer_load_dwordx2 v[162:163], v6, s[16:19], 0 offen offset:3064
    s_bitcmp1_b32 s3, 0
    s_cselect_b32 s24, s28, s24
    s_cselect_b32 s25, s29, s25
    s_movk_i32 s12, 6144
    s_movk_i32 s13, 12288
    s_movk_i32 s14, 18432
    s_movk_i32 s15, 3072
    s_cmp_lg_u32 s3, 1
    s_cbranch_scc1 .Lnw_1
    s_call_b64 s[48:49], .Lpad_0
.Lnw_1:
    s_mov_b32 s62, 0xffff0000
    s_waitcnt vmcnt(28)
    v_lshlrev_b32 v56, 16, v8
    v_and_b32 v60, s62, v8
    v_lshlrev_b32 v64, 16, v9
    v_and_b32 v68, s62, v9
    v_lshlrev_b32 v57, 16, v10
    v_and_b32 v61, s62, v10
    v_lshlrev_b32 v65, 16, v11
    v_and_b32 v69, s62, v11
    s_waitcnt vmcnt(27)
    v_lshlrev_b32 v58, 16, v12
    v_and_b32 v62, s62, v12
    v_lshlrev_b32 v66, 16, v13
    v_and_b32 v70, s62, v13
    v_lshlrev_b32 v59, 16, v14
    v_and_b32 v63, s62, v14
    v_lshlrev_b32 v67, 16, v15
    v_and_b32 v71, s62, v15
    s_waitcnt vmcnt(26)
    v_lshlrev_b32 v72, 16, v16
    v_and_b32 v73, s62, v16
    v_lshlrev_b32 v74, 16, v17
    v_and_b32 v75, s62, v17
    s_waitcnt vmcnt(25)
    v_lshlrev_b32 v76, 16, v18
    v_and_b32 v77, s62, v18
    v_lshlrev_b32 v78, 16, v19
    v_and_b32 v79, s62, v19
    s_waitcnt vmcnt(24)
    v_lshlrev_b32 v80, 16, v20
    v_and_b32 v81, s62, v20
    v_lshlrev_b32 v82, 16, v21
    v_and_b32 v83, s62, v21
    s_waitcnt vmcnt(23)
    v_lshlrev_b32 v84, 16, v22
    v_and_b32 v85, s62, v22
    v_lshlrev_b32 v86, 16, v23
    v_and_b32 v87, s62, v23
    v_pk_mul_f32 v[168:169], v[72:73], v[68:69]
    v_pk_mul_f32 v[170:171], v[74:75], v[70:71]
    s_waitcnt vmcnt(22)
    v_lshlrev_b32 v200, 16, v38
    v_and_b32 v201, s62, v38
    v_lshlrev_b32 v202, 16, v39
    v_and_b32_e64 v203, s62, v39
    v_pk_fma_f32 v[168:169], v[76:77], v[64:65], v[168:169]
    v_pk_fma_f32 v[170:171], v[78:79], v[66:67], v[170:171]
    v_pk_fma_f32 v[168:169], v[80:81], v[60:61], v[168:169]
    v_pk_fma_f32 v[170:171], v[82:83], v[62:63], v[170:171]
    v_pk_fma_f32 v[168:169], v[84:85], v[56:57], v[168:169]
    v_pk_fma_f32 v[170:171], v[86:87], v[58:59], v[170:171]
    v_pk_mul_f32 v[168:169], v[168:169], v[200:201]
    v_pk_mul_f32 v[170:171], v[170:171], v[202:203]
    s_waitcnt vmcnt(21)
    v_lshlrev_b32 v88, 16, v24
    v_and_b32 v89, s62, v24
    v_lshlrev_b32 v90, 16, v25
    v_and_b32_e64 v91, s62, v25
    v_pk_mul_f32 v[172:173], v[76:77], v[68:69]
    v_pk_mul_f32 v[174:175], v[78:79], v[70:71]
    s_waitcnt vmcnt(20)
    v_lshlrev_b32 v204, 16, v40
    v_and_b32 v205, s62, v40
    v_lshlrev_b32 v206, 16, v41
    v_and_b32_e64 v207, s62, v41
    v_pk_fma_f32 v[172:173], v[80:81], v[64:65], v[172:173]
    v_pk_fma_f32 v[174:175], v[82:83], v[66:67], v[174:175]
    v_pk_fma_f32 v[172:173], v[84:85], v[60:61], v[172:173]
    v_pk_fma_f32 v[174:175], v[86:87], v[62:63], v[174:175]
    v_pk_fma_f32 v[172:173], v[88:89], v[56:57], v[172:173]
    v_pk_fma_f32 v[174:175], v[90:91], v[58:59], v[174:175]
    v_pk_mul_f32 v[172:173], v[172:173], v[204:205]
    v_pk_mul_f32 v[174:175], v[174:175], v[206:207]
    v_cvt_pk_bf16_f32 v123, v172, v168
    v_cvt_pk_bf16_f32 v127, v173, v169
    v_cvt_pk_bf16_f32 v131, v174, v170
    v_cvt_pk_bf16_f32 v135, v175, v171
    s_waitcnt vmcnt(19)
    v_lshlrev_b32 v92, 16, v26
    v_and_b32 v93, s62, v26
    v_lshlrev_b32 v94, 16, v27
    v_and_b32_e64 v95, s62, v27
    v_pk_mul_f32 v[176:177], v[80:81], v[68:69]
    v_pk_mul_f32 v[178:179], v[82:83], v[70:71]
    s_waitcnt vmcnt(18)
    v_lshlrev_b32 v200, 16, v42
    v_and_b32 v201, s62, v42
    v_lshlrev_b32 v202, 16, v43
    v_and_b32_e64 v203, s62, v43
    v_pk_fma_f32 v[176:177], v[84:85], v[64:65], v[176:177]
    v_pk_fma_f32 v[178:179], v[86:87], v[66:67], v[178:179]
    v_pk_fma_f32 v[176:177], v[88:89], v[60:61], v[176:177]
    v_pk_fma_f32 v[178:179], v[90:91], v[62:63], v[178:179]
    v_pk_fma_f32 v[176:177], v[92:93], v[56:57], v[176:177]
    v_pk_fma_f32 v[178:179], v[94:95], v[58:59], v[178:179]
    v_pk_mul_f32 v[176:177], v[176:177], v[200:201]
    v_pk_mul_f32 v[178:179], v[178:179], v[202:203]
    s_waitcnt vmcnt(17)
    v_lshlrev_b32 v96, 16, v28
    v_and_b32 v97, s62, v28
    v_lshlrev_b32 v98, 16, v29
    v_and_b32_e64 v99, s62, v29
    v_pk_mul_f32 v[180:181], v[84:85], v[68:69]
    v_pk_mul_f32 v[182:183], v[86:87], v[70:71]
    s_waitcnt vmcnt(16)
    v_lshlrev_b32 v204, 16, v44
    v_and_b32 v205, s62, v44
    v_lshlrev_b32 v206, 16, v45
    v_and_b32_e64 v207, s62, v45
    v_pk_fma_f32 v[180:181], v[88:89], v[64:65], v[180:181]
    v_pk_fma_f32 v[182:183], v[90:91], v[66:67], v[182:183]
    v_pk_fma_f32 v[180:181], v[92:93], v[60:61], v[180:181]
    v_pk_fma_f32 v[182:183], v[94:95], v[62:63], v[182:183]
    v_pk_fma_f32 v[180:181], v[96:97], v[56:57], v[180:181]
    v_pk_fma_f32 v[182:183], v[98:99], v[58:59], v[182:183]
    v_pk_mul_f32 v[180:181], v[180:181], v[204:205]
    v_pk_mul_f32 v[182:183], v[182:183], v[206:207]
    v_cvt_pk_bf16_f32 v122, v180, v176
    v_cvt_pk_bf16_f32 v126, v181, v177
    v_cvt_pk_bf16_f32 v130, v182, v178
    v_cvt_pk_bf16_f32 v134, v183, v179
    s_waitcnt vmcnt(15)
    v_lshlrev_b32 v100, 16, v30
    v_and_b32 v101, s62, v30
    v_lshlrev_b32 v102, 16, v31
    v_and_b32_e64 v103, s62, v31
    v_pk_mul_f32 v[184:185], v[88:89], v[68:69]
    v_pk_mul_f32 v[186:187], v[90:91], v[70:71]
    s_waitcnt vmcnt(14)
    v_lshlrev_b32 v200, 16, v46
    v_and_b32 v201, s62, v46
    v_lshlrev_b32 v202, 16, v47
    v_and_b32_e64 v203, s62, v47
    v_pk_fma_f32 v[184:185], v[92:93], v[64:65], v[184:185]
    v_pk_fma_f32 v[186:187], v[94:95], v[66:67], v[186:187]
    v_pk_fma_f32 v[184:185], v[96:97], v[60:61], v[184:185]
    v_pk_fma_f32 v[186:187], v[98:99], v[62:63], v[186:187]
    v_pk_fma_f32 v[184:185], v[100:101], v[56:57], v[184:185]
    v_pk_fma_f32 v[186:187], v[102:103], v[58:59], v[186:187]
    v_pk_mul_f32 v[184:185], v[184:185], v[200:201]
    v_pk_mul_f32 v[186:187], v[186:187], v[202:203]
    s_load_dword s73, s[40:41], 0x80
    s_waitcnt vmcnt(13)
    v_lshlrev_b32 v104, 16, v32
    v_and_b32 v105, s62, v32
    v_lshlrev_b32 v106, 16, v33
    v_and_b32_e64 v107, s62, v33
    v_pk_mul_f32 v[188:189], v[92:93], v[68:69]
    v_pk_mul_f32 v[190:191], v[94:95], v[70:71]
    s_waitcnt vmcnt(12)
    v_lshlrev_b32 v204, 16, v48
    v_and_b32 v205, s62, v48
    v_lshlrev_b32 v206, 16, v49
    v_and_b32_e64 v207, s62, v49
    v_pk_fma_f32 v[188:189], v[96:97], v[64:65], v[188:189]
    v_pk_fma_f32 v[190:191], v[98:99], v[66:67], v[190:191]
    v_pk_fma_f32 v[188:189], v[100:101], v[60:61], v[188:189]
    v_pk_fma_f32 v[190:191], v[102:103], v[62:63], v[190:191]
    v_pk_fma_f32 v[188:189], v[104:105], v[56:57], v[188:189]
    v_pk_fma_f32 v[190:191], v[106:107], v[58:59], v[190:191]
    v_pk_mul_f32 v[188:189], v[188:189], v[204:205]
    v_pk_mul_f32 v[190:191], v[190:191], v[206:207]
    v_cvt_pk_bf16_f32 v121, v188, v184
    v_cvt_pk_bf16_f32 v125, v189, v185
    v_cvt_pk_bf16_f32 v129, v190, v186
    v_cvt_pk_bf16_f32 v133, v191, v187
    s_waitcnt vmcnt(11)
    v_lshlrev_b32 v108, 16, v34
    v_and_b32 v109, s62, v34
    v_lshlrev_b32 v110, 16, v35
    v_and_b32_e64 v111, s62, v35
    v_pk_mul_f32 v[192:193], v[96:97], v[68:69]
    v_pk_mul_f32 v[194:195], v[98:99], v[70:71]
    s_waitcnt vmcnt(10)
    v_lshlrev_b32 v200, 16, v50
    v_and_b32 v201, s62, v50
    v_lshlrev_b32 v202, 16, v51
    v_and_b32_e64 v203, s62, v51
    v_pk_fma_f32 v[192:193], v[100:101], v[64:65], v[192:193]
    v_pk_fma_f32 v[194:195], v[102:103], v[66:67], v[194:195]
    v_pk_fma_f32 v[192:193], v[104:105], v[60:61], v[192:193]
    v_pk_fma_f32 v[194:195], v[106:107], v[62:63], v[194:195]
    v_pk_fma_f32 v[192:193], v[108:109], v[56:57], v[192:193]
    v_pk_fma_f32 v[194:195], v[110:111], v[58:59], v[194:195]
    v_pk_mul_f32 v[192:193], v[192:193], v[200:201]
    v_pk_mul_f32 v[194:195], v[194:195], v[202:203]
    s_waitcnt vmcnt(9)
    v_lshlrev_b32 v112, 16, v36
    v_and_b32 v113, s62, v36
    v_lshlrev_b32 v114, 16, v37
    v_and_b32_e64 v115, s62, v37
    v_pk_mul_f32 v[196:197], v[100:101], v[68:69]
    v_pk_mul_f32 v[198:199], v[102:103], v[70:71]
    s_waitcnt vmcnt(8)
    v_lshlrev_b32 v204, 16, v52
    v_and_b32 v205, s62, v52
    v_lshlrev_b32 v206, 16, v53
    v_and_b32_e64 v207, s62, v53
    v_pk_fma_f32 v[196:197], v[104:105], v[64:65], v[196:197]
    v_pk_fma_f32 v[198:199], v[106:107], v[66:67], v[198:199]
    v_pk_fma_f32 v[196:197], v[108:109], v[60:61], v[196:197]
    v_pk_fma_f32 v[198:199], v[110:111], v[62:63], v[198:199]
    v_pk_fma_f32 v[196:197], v[112:113], v[56:57], v[196:197]
    v_pk_fma_f32 v[198:199], v[114:115], v[58:59], v[198:199]
    v_pk_mul_f32 v[196:197], v[196:197], v[204:205]
    v_pk_mul_f32 v[198:199], v[198:199], v[206:207]
    v_cvt_pk_bf16_f32 v120, v196, v192
    v_cvt_pk_bf16_f32 v124, v197, v193
    v_cvt_pk_bf16_f32 v128, v198, v194
    v_cvt_pk_bf16_f32 v132, v199, v195
    ds_write_b128 v232, v[120:123] offset:0
    ds_write_b128 v232, v[124:127] offset:64
    ds_write_b128 v232, v[128:131] offset:128
    ds_write_b128 v232, v[132:135] offset:192
    ds_read_b128 v[168:171], v233 offset:0
    ds_read_b128 v[172:175], v233 offset:1088
    ds_read_b128 v[176:179], v233 offset:2176
    ds_read_b128 v[180:183], v233 offset:3264
    s_waitcnt lgkmcnt(0)
    s_mov_b32 s67, s73
    s_cmp_lt_u32 s67, 1
    s_cbranch_scc1 .Lslow_2
.Lback_3:
    s_and_b32 s0, s67, 2
    s_lshl_b32 s0, s0, 20
    s_add_u32 s44, s44, s0
    s_addc_u32 s45, s45, 0
    buffer_load_dword v246, off, s[40:43], 0 sc1
    s_mov_b32 s60, 4194304
    buffer_store_dwordx4 v[168:171], v234, s[44:47], s60 offen sc1
    s_add_u32 s60, s60, 131072
    buffer_store_dwordx4 v[172:175], v234, s[44:47], s60 offen sc1
    s_add_u32 s60, s60, 131072
    buffer_store_dwordx4 v[176:179], v234, s[44:47], s60 offen sc1
    s_add_u32 s60, s60, 131072
    buffer_store_dwordx4 v[180:183], v234, s[44:47], s60 offen sc1
    ds_write_b128 v241, v[224:227]
    ds_write_b128 v243, v[224:227]
    s_and_b32 s61, s3, 1
    s_lshl_b32 s61, s61, 4
    s_lshr_b32 s71, s71, s61
    s_and_b32 s71, s71, 0xffff
    v_sub_u32 v5, 7, v242
    v_and_b32 v7, 1, v5
    v_lshlrev_b32 v7, 4, v7
    v_lshlrev_b32 v7, v7, s71
    v_bfe_u32 v1, v0, 3, 1
    v_add_u32 v1, 2, v1
    v_cmp_eq_u32 vcc, v1, v4
    s_nop 1
    v_cndmask_b32 v7, 0, v7, vcc
    v_lshrrev_b32 v5, 1, v5
    v_cmp_eq_u32 vcc, 0, v5
    s_nop 1
    v_cndmask_b32 v1, 0, v7, vcc
    v_accvgpr_write_b32 a240, v1
    v_cmp_eq_u32 vcc, 1, v5
    s_nop 1
    v_cndmask_b32_e64 v1, 0, v7, vcc
    v_accvgpr_write_b32 a241, v1
    v_cmp_eq_u32 vcc, 2, v5
    s_nop 1
    v_cndmask_b32_e64 v1, 0, v7, vcc
    v_accvgpr_write_b32 a242, v1
    v_cmp_eq_u32 vcc, 3, v5
    s_nop 1
    v_cndmask_b32_e64 v1, 0, v7, vcc
    v_accvgpr_write_b32 a243, v1
    s_waitcnt vmcnt(0)
    s_barrier
    s_and_b32 s60, s1, 0x2000
    s_branch .Lover_0
.Lpad_0:
    s_setpc_b64 s[48:49]
.Lover_0:
    s_add_u32 s60, s60, 1024
    s_cmp_lt_u32 s52, 8
    s_cselect_b32 s60, s1, s60
    s_cmp_lg_u32 s3, 0
    s_cbranch_scc1 .Lnw0_4
    s_mov_b64 exec, 1
    v_readfirstlane_b32 s67, v246
    s_nop 1
    s_cmp_lt_u32 s67, 1
    s_cbranch_scc1 .Lslow_5
.Lback_6:
    s_mov_b32 s75, 1
    s_atomic_add s75, s[44:45], s60 glc
    s_mov_b64 exec, -1
.Lnw0_4:
    v_and_b32 v250, 56, v0
    v_add_u32_e64 v250, s68, v250
    v_subrev_u32 v249, 640, v250
    v_min_u32_e64 v250, v250, v249
    v_mad_u32_u24 v254, v250, s15, v253
    s_add_u32 s68, s68, 128
    buffer_load_dwordx4 v[8:11], v254, s[24:27], 0 offen offset:0
    buffer_load_dwordx4 v[12:15], v254, s[24:27], 0 offen offset:3072
    buffer_load_dwordx4 v[16:19], v254, s[24:27], s12 offen offset:0
    buffer_load_dwordx4 v[20:23], v254, s[24:27], s12 offen offset:3072
    buffer_load_dwordx4 v[24:27], v254, s[24:27], s13 offen offset:0
    buffer_load_dwordx4 v[28:31], v254, s[24:27], s13 offen offset:3072
    buffer_load_dwordx4 v[32:35], v254, s[24:27], s14 offen offset:0
    buffer_load_dwordx4 v[36:39], v254, s[24:27], s14 offen offset:3072
    ds_write_b128 v235, v[140:143] offset:12416
    v_pk_mov_b32 v[192:193], v[138:139], v[140:141] op_sel:[1,0]
    v_pk_mov_b32 v[194:195], v[140:141], v[142:143] op_sel:[1,0]
    v_alignbit_b32 v184, v139, v138, 16
    v_alignbit_b32 v185, v140, v139, 16
    v_alignbit_b32 v186, v141, v140, 16
    v_alignbit_b32 v187, v142, v141, 16
    ds_write_b128 v235, v[192:195] offset:4160
    ds_write_b128 v235, v[184:187] offset:32
    v_alignbit_b32 v188, v140, v139, 16
    v_alignbit_b32 v189, v141, v140, 16
    v_alignbit_b32 v190, v142, v141, 16
    v_alignbit_b32 v191, v143, v142, 16
    ds_write_b128 v235, v[188:191] offset:8288
    ds_write_b128 v235, v[148:151] offset:13440
    v_pk_mov_b32 v[204:205], v[146:147], v[148:149] op_sel:[1,0]
    v_pk_mov_b32 v[206:207], v[148:149], v[150:151] op_sel:[1,0]
    v_alignbit_b32 v196, v147, v146, 16
    v_alignbit_b32 v197, v148, v147, 16
    v_alignbit_b32 v198, v149, v148, 16
    v_alignbit_b32 v199, v150, v149, 16
    ds_write_b128 v235, v[204:207] offset:5184
    ds_write_b128 v235, v[196:199] offset:1056
    v_alignbit_b32 v200, v148, v147, 16
    v_alignbit_b32 v201, v149, v148, 16
    v_alignbit_b32 v202, v150, v149, 16
    v_alignbit_b32 v203, v151, v150, 16
    ds_write_b128 v235, v[200:203] offset:9312
    ds_write_b128 v235, v[156:159] offset:14464
    v_pk_mov_b32 v[192:193], v[154:155], v[156:157] op_sel:[1,0]
    v_pk_mov_b32 v[194:195], v[156:157], v[158:159] op_sel:[1,0]
    v_alignbit_b32 v184, v155, v154, 16
    v_alignbit_b32 v185, v156, v155, 16
    v_alignbit_b32 v186, v157, v156, 16
    v_alignbit_b32 v187, v158, v157, 16
    ds_write_b128 v235, v[192:195] offset:6208
    ds_write_b128 v235, v[184:187] offset:2080
    v_alignbit_b32 v188, v156, v155, 16
    v_alignbit_b32 v189, v157, v156, 16
    v_alignbit_b32 v190, v158, v157, 16
    v_alignbit_b32 v191, v159, v158, 16
    ds_write_b128 v235, v[188:191] offset:10336
    ds_write_b128 v235, v[164:167] offset:15488
    v_pk_mov_b32 v[204:205], v[162:163], v[164:165] op_sel:[1,0]
    v_pk_mov_b32 v[206:207], v[164:165], v[166:167] op_sel:[1,0]
    v_alignbit_b32 v196, v163, v162, 16
    v_alignbit_b32 v197, v164, v163, 16
    v_alignbit_b32 v198, v165, v164, 16
    v_alignbit_b32 v199, v166, v165, 16
    ds_write_b128 v235, v[204:207] offset:7232
    ds_write_b128 v235, v[196:199] offset:3104
    v_alignbit_b32 v200, v164, v163, 16
    v_alignbit_b32 v201, v165, v164, 16
    v_alignbit_b32 v202, v166, v165, 16
    v_alignbit_b32 v203, v167, v166, 16
    ds_write_b128 v235, v[200:203] offset:11360
    ds_read2_b64 a[0:3], v237 offset0:0 offset1:1
    ds_read2_b64 a[4:7], v237 offset0:64 offset1:65
    ds_read2_b64 a[8:11], v237 offset0:128 offset1:129
    ds_read2_b64 a[12:15], v237 offset0:192 offset1:193
    ds_read2_b64 a[16:19], v239 offset0:0 offset1:1
    ds_read2_b64 a[20:23], v239 offset0:64 offset1:65
    ds_read2_b64 a[24:27], v239 offset0:128 offset1:129
    ds_read2_b64 a[28:31], v239 offset0:192 offset1:193
    s_cmp_lg_u32 s3, 1
    s_cbranch_scc1 .Lnw_7
    s_call_b64 s[48:49], .Lpad_1
    s_call_b64 s[48:49], .Lpad_4
.Lnw_7:
    s_cmp_lg_u32 s3, 2
    s_cbranch_scc1 .Lnw_8
    s_call_b64 s[48:49], .Lpad_2
    s_call_b64 s[48:49], .Lpad_5
.Lnw_8:
    s_cmp_lg_u32 s3, 3
    s_cbranch_scc1 .Lnw_9
    s_call_b64 s[48:49], .Lpad_3
.Lnw_9:
    s_cmp_lg_u32 s3, 0
    s_cbranch_scc1 .Lnw0_10
    s_mov_b64 exec, 1
    s_mov_b32 s70, 100000
    s_waitcnt lgkmcnt(0)
    s_cmp_ge_u32 s75, 15
    s_cbranch_scc1 .Ldone_12
.Lspin_11:
    s_mov_b32 s75, 0
    s_atomic_add s75, s[44:45], s60 glc
    s_sub_u32 s70, s70, 1
    s_cbranch_scc1 .Ldone_12
    s_waitcnt lgkmcnt(0)
    s_cmp_lt_u32 s75, 16
    s_cbranch_scc1 .Lspin_11
.Ldone_12:
    s_waitcnt lgkmcnt(0)
    s_mov_b64 exec, -1
.Lnw0_10:
    s_barrier
    s_mov_b32 s60, 4194304
    buffer_load_dwordx4 a[64:67], v240, s[44:47], s60 offen sc1
    s_add_u32 s60, s60, 4096
    buffer_load_dwordx4 a[68:71], v240, s[44:47], s60 offen sc1
    s_add_u32 s60, s60, 12288
    buffer_load_dwordx4 a[72:75], v240, s[44:47], s60 offen sc1
    s_add_u32 s60, s60, 4096
    buffer_load_dwordx4 a[76:79], v240, s[44:47], s60 offen sc1
    s_lshr_b32 s60, s3, 1
    s_lshl_b32 s60, s60, 12
    s_and_b32 s61, s3, 1
    s_lshl_b32 s61, s61, 7
    s_add_u32 s60, s60, s61
    v_lshrrev_b32 v250, 3, v0
    v_lshl_add_u32 v250, v250, 9, s60
    v_and_b32_e64 v249, 1, v0
    v_lshl_add_u32 v250, v249, 6, v250
    v_bfe_u32 v249, v0, 1, 2
    s_mov_b32 s60, 40976
    v_mad_u32_u24 v232, v249, s60, v250
    v_xor_b32 v233, 16, v232
    v_xor_b32 v234, 32, v232
    v_xor_b32_e64 v243, 48, v232
    s_mov_b32 s16, 0x05040100
    s_mov_b32 s17, 0x07060302
    v_add_u32 v247, 81920, v238
    s_waitcnt vmcnt(10)
    v_perm_b32 v200, v12, v8, s16
    s_waitcnt vmcnt(8)
    v_perm_b32 v201, v20, v16, s16
    s_waitcnt vmcnt(6)
    v_perm_b32 v202, v28, v24, s16
    s_waitcnt vmcnt(4)
    v_perm_b32 v203, v36, v32, s16
    ds_write_b128 v232, v[200:203] offset:0
    v_perm_b32 v204, v12, v8, s17
    v_perm_b32 v205, v20, v16, s17
    v_perm_b32 v206, v28, v24, s17
    v_perm_b32 v207, v36, v32, s17
    ds_write_b128 v233, v[204:207] offset:0
    v_perm_b32 v208, v13, v9, s16
    v_perm_b32 v209, v21, v17, s16
    v_perm_b32 v210, v29, v25, s16
    v_perm_b32 v211, v37, v33, s16
    ds_write_b128 v234, v[208:211] offset:0
    v_perm_b32 v212, v13, v9, s17
    v_perm_b32 v213, v21, v17, s17
    v_perm_b32 v214, v29, v25, s17
    v_perm_b32 v215, v37, v33, s17
    ds_write_b128 v243, v[212:215] offset:0
    v_perm_b32 v200, v14, v10, s16
    v_perm_b32 v201, v22, v18, s16
    v_perm_b32 v202, v30, v26, s16
    v_perm_b32 v203, v38, v34, s16
    ds_write_b128 v232, v[200:203] offset:256
    v_perm_b32 v204, v14, v10, s17
    v_perm_b32 v205, v22, v18, s17
    v_perm_b32 v206, v30, v26, s17
    v_perm_b32 v207, v38, v34, s17
    ds_write_b128 v233, v[204:207] offset:256
    v_perm_b32 v208, v15, v11, s16
    v_perm_b32 v209, v23, v19, s16
    v_perm_b32 v210, v31, v27, s16
    v_perm_b32 v211, v39, v35, s16
    ds_write_b128 v234, v[208:211] offset:256
    v_perm_b32 v212, v15, v11, s17
    v_perm_b32 v213, v23, v19, s17
    v_perm_b32 v214, v31, v27, s17
    v_perm_b32 v215, v39, v35, s17
    ds_write_b128 v243, v[212:215] offset:256
    s_add_u32 s63, s1, 4096
    s_mov_b32 s64, 12582912
    s_cmp_lt_u32 s52, 8
    s_cselect_b32 s64, s64, 4718592
    s_add_u32 s66, s66, s64
    s_lshr_b32 s64, s3, 1
    s_lshl_b32 s64, s64, 13
    s_add_u32 s66, s66, s64
    s_mov_b32 s64, 49152
    s_waitcnt vmcnt(3)
    ds_write_b128 v241, a[64:67] offset:512
    ds_read_b128 a[32:35], v236 offset:448
    ds_read_b128 a[36:39], v236 offset:960
    s_waitcnt vmcnt(2)
    ds_write_b128 v241, a[68:71] offset:1536
    ds_read_b128 a[40:43], v236 offset:1472
    ds_read_b128 a[44:47], v236 offset:1984
    s_waitcnt vmcnt(1)
    ds_write_b128 v241, a[72:75] offset:2560
    ds_read_b128 a[48:51], v236 offset:2496
    ds_read_b128 a[52:55], v236 offset:3008
    s_waitcnt vmcnt(0)
    ds_write_b128 v241, a[76:79] offset:3584
    ds_read_b128 a[56:59], v236 offset:3520
    ds_read_b128 a[60:63], v236 offset:4032
    s_waitcnt lgkmcnt(10)
    v_mfma_f32_16x16x32_bf16 a[128:131], a[240:243], a[32:35], 0
    v_mov_b32_e64 v228, -1
    v_mfma_f32_16x16x32_bf16 a[128:131], a[0:3], a[32:35], a[128:131]
    v_mov_b32 v229, -1
    s_waitcnt lgkmcnt(9)
    v_mfma_f32_16x16x32_bf16 a[132:135], a[240:243], a[36:39], 0
    s_lshl_b32 s73, s56, 8
    v_mfma_f32_16x16x32_bf16 a[132:135], a[0:3], a[36:39], a[132:135]
    s_add_u32 s73, s73, 131072
    v_mfma_f32_16x16x32_bf16 a[132:135], a[4:7], a[32:35], a[132:135]
    s_mov_b32 exec_hi, 0
    buffer_store_dwordx2 v[228:229], v251, s[44:47], s73 offen sc1
    s_mov_b32 exec_hi, -1
    s_waitcnt lgkmcnt(7)
    v_mfma_f32_16x16x32_bf16 a[136:139], a[240:243], a[40:43], 0
    v_mfma_f32_16x16x32_bf16 a[136:139], a[0:3], a[40:43], a[136:139]
    v_mfma_f32_16x16x32_bf16 a[136:139], a[4:7], a[36:39], a[136:139]
    v_mfma_f32_16x16x32_bf16 a[136:139], a[8:11], a[32:35], a[136:139]
    ds_read2_b64 a[64:67], v237 offset0:8 offset1:9
    s_nop 0
    s_waitcnt lgkmcnt(7)
    v_mfma_f32_16x16x32_bf16 a[140:143], a[240:243], a[44:47], 0
    v_mfma_f32_16x16x32_bf16 a[140:143], a[0:3], a[44:47], a[140:143]
    ds_read_b128 a[96:99], v236 offset:384
    v_and_b32 v250, 56, v0
    v_add_u32 v250, s68, v250
    v_mfma_f32_16x16x32_bf16 a[140:143], a[4:7], a[40:43], a[140:143]
    v_subrev_u32 v249, 640, v250
    v_min_u32_e64 v250, v250, v249
    v_mfma_f32_16x16x32_bf16 a[140:143], a[8:11], a[36:39], a[140:143]
    ds_read2_b64 a[68:71], v237 offset0:72 offset1:73
    v_mad_u32_u24 v254, v250, s15, v253
    s_add_u32 s68, s68, 128
    v_mfma_f32_16x16x32_bf16 a[140:143], a[12:15], a[32:35], a[140:143]
    buffer_load_dwordx4 v[40:43], v254, s[24:27], 0 offen offset:0
    s_nop 0
    s_waitcnt lgkmcnt(7)
    v_mfma_f32_16x16x32_bf16 a[144:147], a[240:243], a[48:51], 0
    ds_read_b128 a[100:103], v236 offset:896
    v_mfma_f32_16x16x32_bf16 a[144:147], a[0:3], a[48:51], a[144:147]
    v_mfma_f32_16x16x32_bf16 a[144:147], a[4:7], a[44:47], a[144:147]
    ds_read2_b64 a[72:75], v237 offset0:136 offset1:137
    v_mfma_f32_16x16x32_bf16 a[144:147], a[8:11], a[40:43], a[144:147]
    v_mfma_f32_16x16x32_bf16 a[144:147], a[12:15], a[36:39], a[144:147]
    ds_read_b128 a[104:107], v236 offset:1408
    v_mfma_f32_16x16x32_bf16 a[144:147], a[16:19], a[32:35], a[144:147]
    buffer_load_dwordx4 v[44:47], v254, s[24:27], 0 offen offset:3072
    s_nop 0
    s_waitcnt lgkmcnt(9)
    v_mfma_f32_16x16x32_bf16 a[148:151], a[240:243], a[52:55], 0
    ds_read2_b64 a[76:79], v237 offset0:200 offset1:201
    v_mfma_f32_16x16x32_bf16 a[148:151], a[0:3], a[52:55], a[148:151]
    v_mfma_f32_16x16x32_bf16 a[148:151], a[4:7], a[48:51], a[148:151]
    ds_read_b128 a[108:111], v236 offset:1920
    v_mfma_f32_16x16x32_bf16 a[148:151], a[8:11], a[44:47], a[148:151]
    v_mfma_f32_16x16x32_bf16 a[148:151], a[12:15], a[40:43], a[148:151]
    ds_read2_b64 a[80:83], v239 offset0:8 offset1:9
    v_mfma_f32_16x16x32_bf16 a[148:151], a[16:19], a[36:39], a[148:151]
    buffer_load_dwordx4 v[48:51], v254, s[24:27], s12 offen offset:0
    v_mfma_f32_16x16x32_bf16 a[148:151], a[20:23], a[32:35], a[148:151]
    ds_read_b128 a[112:115], v236 offset:2432
    s_nop 0
    s_waitcnt lgkmcnt(11)
    v_mfma_f32_16x16x32_bf16 a[152:155], a[240:243], a[56:59], 0
    v_mfma_f32_16x16x32_bf16 a[152:155], a[0:3], a[56:59], a[152:155]
    ds_read2_b64 a[84:87], v239 offset0:72 offset1:73
    v_mfma_f32_16x16x32_bf16 a[152:155], a[4:7], a[52:55], a[152:155]
    v_mfma_f32_16x16x32_bf16 a[152:155], a[8:11], a[48:51], a[152:155]
    ds_read_b128 a[116:119], v236 offset:2944
    v_mfma_f32_16x16x32_bf16 a[152:155], a[12:15], a[44:47], a[152:155]
    buffer_load_dwordx4 v[52:55], v254, s[24:27], s12 offen offset:3072
    v_mfma_f32_16x16x32_bf16 a[152:155], a[16:19], a[40:43], a[152:155]
    ds_read2_b64 a[88:91], v239 offset0:136 offset1:137
    v_mfma_f32_16x16x32_bf16 a[152:155], a[20:23], a[36:39], a[152:155]
    v_mfma_f32_16x16x32_bf16 a[152:155], a[24:27], a[32:35], a[152:155]
    ds_read_b128 a[120:123], v236 offset:3456
    s_nop 0
    s_waitcnt lgkmcnt(14)
    v_mfma_f32_16x16x32_bf16 a[156:159], a[240:243], a[60:63], 0
    v_mfma_f32_16x16x32_bf16 a[156:159], a[0:3], a[60:63], a[156:159]
    ds_read2_b64 a[92:95], v239 offset0:200 offset1:201
    v_mfma_f32_16x16x32_bf16 a[156:159], a[4:7], a[56:59], a[156:159]
    buffer_load_dwordx4 v[56:59], v254, s[24:27], s13 offen offset:0
    v_mfma_f32_16x16x32_bf16 a[156:159], a[8:11], a[52:55], a[156:159]
    ds_read_b128 a[124:127], v236 offset:3968
    v_mfma_f32_16x16x32_bf16 a[156:159], a[12:15], a[48:51], a[156:159]
    v_mfma_f32_16x16x32_bf16 a[156:159], a[16:19], a[44:47], a[156:159]
    v_mfma_f32_16x16x32_bf16 a[156:159], a[20:23], a[40:43], a[156:159]
    v_mfma_f32_16x16x32_bf16 a[156:159], a[24:27], a[36:39], a[156:159]
    v_mfma_f32_16x16x32_bf16 a[156:159], a[28:31], a[32:35], a[156:159]
    buffer_load_dwordx4 v[60:63], v254, s[24:27], s13 offen offset:3072
    s_nop 0
    s_waitcnt lgkmcnt(4)
    v_mfma_f32_16x16x32_bf16 a[128:131], a[64:67], a[96:99], a[128:131]
    ds_read2_b64 a[0:3], v237 offset0:16 offset1:17
    v_mfma_f32_16x16x32_bf16 a[132:135], a[64:67], a[100:103], a[132:135]
    v_mfma_f32_16x16x32_bf16 a[132:135], a[68:71], a[96:99], a[132:135]
    ds_read_b128 a[32:35], v236 offset:320
    v_mfma_f32_16x16x32_bf16 a[136:139], a[64:67], a[104:107], a[136:139]
    v_mfma_f32_16x16x32_bf16 a[136:139], a[68:71], a[100:103], a[136:139]
    ds_read2_b64 a[4:7], v237 offset0:80 offset1:81
    v_mfma_f32_16x16x32_bf16 a[136:139], a[72:75], a[96:99], a[136:139]
    buffer_load_dwordx4 v[64:67], v254, s[24:27], s14 offen offset:0
    v_mfma_f32_16x16x32_bf16 a[140:143], a[64:67], a[108:111], a[140:143]
    ds_read_b128 a[36:39], v236 offset:832
    v_mfma_f32_16x16x32_bf16 a[140:143], a[68:71], a[104:107], a[140:143]
    v_mfma_f32_16x16x32_bf16 a[140:143], a[72:75], a[100:103], a[140:143]
    ds_read2_b64 a[8:11], v237 offset0:144 offset1:145
    v_mfma_f32_16x16x32_bf16 a[140:143], a[76:79], a[96:99], a[140:143]
    v_mfma_f32_16x16x32_bf16 a[144:147], a[64:67], a[112:115], a[144:147]
    ds_read_b128 a[40:43], v236 offset:1344
    buffer_load_dwordx4 v[68:71], v254, s[24:27], s14 offen offset:3072
    v_mfma_f32_16x16x32_bf16 a[144:147], a[68:71], a[108:111], a[144:147]
    v_mfma_f32_16x16x32_bf16 a[144:147], a[72:75], a[104:107], a[144:147]
    ds_read2_b64 a[12:15], v237 offset0:208 offset1:209
    v_and_b32 v250, 56, v0
    v_add_u32 v250, s68, v250
    v_mfma_f32_16x16x32_bf16 a[144:147], a[76:79], a[100:103], a[144:147]
    v_subrev_u32 v249, 640, v250
    v_min_u32_e64 v250, v250, v249
    v_mfma_f32_16x16x32_bf16 a[144:147], a[80:83], a[96:99], a[144:147]
    ds_read_b128 a[44:47], v236 offset:1856
    v_mad_u32_u24 v254, v250, s15, v253
    s_add_u32 s68, s68, 128
    v_mfma_f32_16x16x32_bf16 a[148:151], a[64:67], a[116:119], a[148:151]
    buffer_load_dwordx4 v[72:75], v254, s[24:27], 0 offen offset:0
    v_mfma_f32_16x16x32_bf16 a[148:151], a[68:71], a[112:115], a[148:151]
    ds_read2_b64 a[16:19], v239 offset0:16 offset1:17
    v_mfma_f32_16x16x32_bf16 a[148:151], a[72:75], a[108:111], a[148:151]
    v_mfma_f32_16x16x32_bf16 a[148:151], a[76:79], a[104:107], a[148:151]
    ds_read_b128 a[48:51], v236 offset:2368
    v_mfma_f32_16x16x32_bf16 a[148:151], a[80:83], a[100:103], a[148:151]
    v_mfma_f32_16x16x32_bf16 a[148:151], a[84:87], a[96:99], a[148:151]
    ds_read2_b64 a[20:23], v239 offset0:80 offset1:81
    buffer_load_dwordx4 v[76:79], v254, s[24:27], 0 offen offset:3072
    s_nop 0
    s_waitcnt lgkmcnt(13)
    v_mfma_f32_16x16x32_bf16 a[152:155], a[64:67], a[120:123], a[152:155]
    v_mfma_f32_16x16x32_bf16 a[152:155], a[68:71], a[116:119], a[152:155]
    ds_read_b128 a[52:55], v236 offset:2880
    v_mfma_f32_16x16x32_bf16 a[152:155], a[72:75], a[112:115], a[152:155]
    v_mfma_f32_16x16x32_bf16 a[152:155], a[76:79], a[108:111], a[152:155]
    ds_read2_b64 a[24:27], v239 offset0:144 offset1:145
    v_mfma_f32_16x16x32_bf16 a[152:155], a[80:83], a[104:107], a[152:155]
    buffer_load_dwordx4 v[80:83], v254, s[24:27], s12 offen offset:0
    v_mfma_f32_16x16x32_bf16 a[152:155], a[84:87], a[100:103], a[152:155]
    ds_read_b128 a[56:59], v236 offset:3392
    v_mfma_f32_16x16x32_bf16 a[152:155], a[88:91], a[96:99], a[152:155]
    s_nop 0
    s_waitcnt lgkmcnt(14)
    v_mfma_f32_16x16x32_bf16 a[156:159], a[64:67], a[124:127], a[156:159]
    ds_read2_b64 a[28:31], v239 offset0:208 offset1:209
    v_mfma_f32_16x16x32_bf16 a[156:159], a[68:71], a[120:123], a[156:159]
    v_mfma_f32_16x16x32_bf16 a[156:159], a[72:75], a[116:119], a[156:159]
    ds_read_b128 a[60:63], v236 offset:3904
    buffer_load_dwordx4 v[84:87], v254, s[24:27], s12 offen offset:3072
    v_mfma_f32_16x16x32_bf16 a[156:159], a[76:79], a[112:115], a[156:159]
    v_mfma_f32_16x16x32_bf16 a[156:159], a[80:83], a[108:111], a[156:159]
    v_mfma_f32_16x16x32_bf16 a[156:159], a[84:87], a[104:107], a[156:159]
    v_mfma_f32_16x16x32_bf16 a[156:159], a[88:91], a[100:103], a[156:159]
    v_mfma_f32_16x16x32_bf16 a[156:159], a[92:95], a[96:99], a[156:159]
    buffer_load_dwordx4 v[88:91], v254, s[24:27], s13 offen offset:0
    s_nop 0
    s_waitcnt lgkmcnt(4)
    v_mfma_f32_16x16x32_bf16 a[128:131], a[0:3], a[32:35], a[128:131]
    ds_read2_b64 a[64:67], v237 offset0:24 offset1:25
    v_mfma_f32_16x16x32_bf16 a[132:135], a[0:3], a[36:39], a[132:135]
    v_mfma_f32_16x16x32_bf16 a[132:135], a[4:7], a[32:35], a[132:135]
    ds_read_b128 a[96:99], v236 offset:256
    v_mfma_f32_16x16x32_bf16 a[136:139], a[0:3], a[40:43], a[136:139]
    v_mfma_f32_16x16x32_bf16 a[136:139], a[4:7], a[36:39], a[136:139]
    ds_read2_b64 a[68:71], v237 offset0:88 offset1:89
    v_mfma_f32_16x16x32_bf16 a[136:139], a[8:11], a[32:35], a[136:139]
    buffer_load_dwordx4 v[92:95], v254, s[24:27], s13 offen offset:3072
    v_mfma_f32_16x16x32_bf16 a[140:143], a[0:3], a[44:47], a[140:143]
    ds_read_b128 a[100:103], v236 offset:768
    v_mfma_f32_16x16x32_bf16 a[140:143], a[4:7], a[40:43], a[140:143]
    v_mfma_f32_16x16x32_bf16 a[140:143], a[8:11], a[36:39], a[140:143]
    ds_read2_b64 a[72:75], v237 offset0:152 offset1:153
    v_mfma_f32_16x16x32_bf16 a[140:143], a[12:15], a[32:35], a[140:143]
    v_mfma_f32_16x16x32_bf16 a[144:147], a[0:3], a[48:51], a[144:147]
    ds_read_b128 a[104:107], v236 offset:1280
    v_mfma_f32_16x16x32_bf16 a[144:147], a[4:7], a[44:47], a[144:147]
    buffer_load_dwordx4 v[96:99], v254, s[24:27], s14 offen offset:0
    v_mfma_f32_16x16x32_bf16 a[144:147], a[8:11], a[40:43], a[144:147]
    ds_read2_b64 a[76:79], v237 offset0:216 offset1:217
    v_mfma_f32_16x16x32_bf16 a[144:147], a[12:15], a[36:39], a[144:147]
    v_mfma_f32_16x16x32_bf16 a[144:147], a[16:19], a[32:35], a[144:147]
    ds_read_b128 a[108:111], v236 offset:1792
    v_mfma_f32_16x16x32_bf16 a[148:151], a[0:3], a[52:55], a[148:151]
    v_mfma_f32_16x16x32_bf16 a[148:151], a[4:7], a[48:51], a[148:151]
    ds_read2_b64 a[80:83], v239 offset0:24 offset1:25
    v_mfma_f32_16x16x32_bf16 a[148:151], a[8:11], a[44:47], a[148:151]
    buffer_load_dwordx4 v[100:103], v254, s[24:27], s14 offen offset:3072
    v_mfma_f32_16x16x32_bf16 a[148:151], a[12:15], a[40:43], a[148:151]
    ds_read_b128 a[112:115], v236 offset:2304
    v_mfma_f32_16x16x32_bf16 a[148:151], a[16:19], a[36:39], a[148:151]
    v_mfma_f32_16x16x32_bf16 a[148:151], a[20:23], a[32:35], a[148:151]
    ds_read2_b64 a[84:87], v239 offset0:88 offset1:89
    v_and_b32_e64 v250, 56, v0
    v_add_u32 v250, s68, v250
    s_waitcnt lgkmcnt(13)
    v_mfma_f32_16x16x32_bf16 a[152:155], a[0:3], a[56:59], a[152:155]
    v_subrev_u32 v249, 640, v250
    v_min_u32_e64 v250, v250, v249
    v_mfma_f32_16x16x32_bf16 a[152:155], a[4:7], a[52:55], a[152:155]
    ds_read_b128 a[116:119], v236 offset:2816
    v_mad_u32_u24 v254, v250, s15, v253
    s_add_u32 s68, s68, 128
    v_mfma_f32_16x16x32_bf16 a[152:155], a[8:11], a[48:51], a[152:155]
    buffer_load_dwordx4 v[104:107], v254, s[24:27], 0 offen offset:0
    v_mfma_f32_16x16x32_bf16 a[152:155], a[12:15], a[44:47], a[152:155]
    ds_read2_b64 a[88:91], v239 offset0:152 offset1:153
    v_mfma_f32_16x16x32_bf16 a[152:155], a[16:19], a[40:43], a[152:155]
    v_mfma_f32_16x16x32_bf16 a[152:155], a[20:23], a[36:39], a[152:155]
    ds_read_b128 a[120:123], v236 offset:3328
    v_mfma_f32_16x16x32_bf16 a[152:155], a[24:27], a[32:35], a[152:155]
    s_nop 0
    s_waitcnt lgkmcnt(14)
    v_mfma_f32_16x16x32_bf16 a[156:159], a[0:3], a[60:63], a[156:159]
    ds_read2_b64 a[92:95], v239 offset0:216 offset1:217
    v_mfma_f32_16x16x32_bf16 a[156:159], a[4:7], a[56:59], a[156:159]
    buffer_load_dwordx4 v[108:111], v254, s[24:27], 0 offen offset:3072
    v_mfma_f32_16x16x32_bf16 a[156:159], a[8:11], a[52:55], a[156:159]
    ds_read_b128 a[124:127], v236 offset:3840
    v_mfma_f32_16x16x32_bf16 a[156:159], a[12:15], a[48:51], a[156:159]
    v_mfma_f32_16x16x32_bf16 a[156:159], a[16:19], a[44:47], a[156:159]
    v_mfma_f32_16x16x32_bf16 a[156:159], a[20:23], a[40:43], a[156:159]
    v_mfma_f32_16x16x32_bf16 a[156:159], a[24:27], a[36:39], a[156:159]
    v_mfma_f32_16x16x32_bf16 a[156:159], a[28:31], a[32:35], a[156:159]
    buffer_load_dwordx4 v[112:115], v254, s[24:27], s12 offen offset:0
    s_nop 0
    s_waitcnt lgkmcnt(4)
    v_mfma_f32_16x16x32_bf16 a[128:131], a[64:67], a[96:99], a[128:131]
    ds_read2_b64 a[0:3], v237 offset0:32 offset1:33
    v_mfma_f32_16x16x32_bf16 a[132:135], a[64:67], a[100:103], a[132:135]
    v_mfma_f32_16x16x32_bf16 a[132:135], a[68:71], a[96:99], a[132:135]
    ds_read_b128 a[32:35], v236 offset:192
    v_mfma_f32_16x16x32_bf16 a[136:139], a[64:67], a[104:107], a[136:139]
    v_mfma_f32_16x16x32_bf16 a[136:139], a[68:71], a[100:103], a[136:139]
    ds_read2_b64 a[4:7], v237 offset0:96 offset1:97
    v_mfma_f32_16x16x32_bf16 a[136:139], a[72:75], a[96:99], a[136:139]
    buffer_load_dwordx4 v[116:119], v254, s[24:27], s12 offen offset:3072
    v_mfma_f32_16x16x32_bf16 a[140:143], a[64:67], a[108:111], a[140:143]
    ds_read_b128 a[36:39], v236 offset:704
    v_mfma_f32_16x16x32_bf16 a[140:143], a[68:71], a[104:107], a[140:143]
    v_mfma_f32_16x16x32_bf16 a[140:143], a[72:75], a[100:103], a[140:143]
    ds_read2_b64 a[8:11], v237 offset0:160 offset1:161
    v_mfma_f32_16x16x32_bf16 a[140:143], a[76:79], a[96:99], a[140:143]
    v_mfma_f32_16x16x32_bf16 a[144:147], a[64:67], a[112:115], a[144:147]
    ds_read_b128 a[40:43], v236 offset:1216
    buffer_load_dwordx4 v[120:123], v254, s[24:27], s13 offen offset:0
    v_mfma_f32_16x16x32_bf16 a[144:147], a[68:71], a[108:111], a[144:147]
    v_mfma_f32_16x16x32_bf16 a[144:147], a[72:75], a[104:107], a[144:147]
    ds_read2_b64 a[12:15], v237 offset0:224 offset1:225
    v_mfma_f32_16x16x32_bf16 a[144:147], a[76:79], a[100:103], a[144:147]
    v_mfma_f32_16x16x32_bf16 a[144:147], a[80:83], a[96:99], a[144:147]
    ds_read_b128 a[44:47], v236 offset:1728
    v_mfma_f32_16x16x32_bf16 a[148:151], a[64:67], a[116:119], a[148:151]
    buffer_load_dwordx4 v[124:127], v254, s[24:27], s13 offen offset:3072
    v_mfma_f32_16x16x32_bf16 a[148:151], a[68:71], a[112:115], a[148:151]
    ds_read2_b64 a[16:19], v239 offset0:32 offset1:33
    v_mfma_f32_16x16x32_bf16 a[148:151], a[72:75], a[108:111], a[148:151]
    v_mfma_f32_16x16x32_bf16 a[148:151], a[76:79], a[104:107], a[148:151]
    ds_read_b128 a[48:51], v236 offset:2240
    v_mfma_f32_16x16x32_bf16 a[148:151], a[80:83], a[100:103], a[148:151]
    v_mfma_f32_16x16x32_bf16 a[148:151], a[84:87], a[96:99], a[148:151]
    ds_read2_b64 a[20:23], v239 offset0:96 offset1:97
    buffer_load_dwordx4 v[128:131], v254, s[24:27], s14 offen offset:0
    s_nop 0
    s_waitcnt lgkmcnt(13)
    v_mfma_f32_16x16x32_bf16 a[152:155], a[64:67], a[120:123], a[152:155]
    v_mfma_f32_16x16x32_bf16 a[152:155], a[68:71], a[116:119], a[152:155]
    ds_read_b128 a[52:55], v236 offset:2752
    v_mfma_f32_16x16x32_bf16 a[152:155], a[72:75], a[112:115], a[152:155]
    v_mfma_f32_16x16x32_bf16 a[152:155], a[76:79], a[108:111], a[152:155]
    ds_read2_b64 a[24:27], v239 offset0:160 offset1:161
    v_mfma_f32_16x16x32_bf16 a[152:155], a[80:83], a[104:107], a[152:155]
    buffer_load_dwordx4 v[132:135], v254, s[24:27], s14 offen offset:3072
    v_mfma_f32_16x16x32_bf16 a[152:155], a[84:87], a[100:103], a[152:155]
    ds_read_b128 a[56:59], v236 offset:3264
    v_mfma_f32_16x16x32_bf16 a[152:155], a[88:91], a[96:99], a[152:155]
    v_and_b32_e64 v250, 56, v0
    v_add_u32 v250, s68, v250
    s_waitcnt lgkmcnt(14)
    v_mfma_f32_16x16x32_bf16 a[156:159], a[64:67], a[124:127], a[156:159]
    ds_read2_b64 a[28:31], v239 offset0:224 offset1:225
    v_subrev_u32 v249, 640, v250
    v_min_u32_e64 v250, v250, v249
    v_mfma_f32_16x16x32_bf16 a[156:159], a[68:71], a[120:123], a[156:159]
    v_mad_u32_u24 v254, v250, s15, v253
    s_add_u32 s68, s68, 128
    v_mfma_f32_16x16x32_bf16 a[156:159], a[72:75], a[116:119], a[156:159]
    ds_read_b128 a[60:63], v236 offset:3776
    buffer_load_dwordx4 v[8:11], v254, s[24:27], 0 offen offset:0
    v_mfma_f32_16x16x32_bf16 a[156:159], a[76:79], a[112:115], a[156:159]
    v_mfma_f32_16x16x32_bf16 a[156:159], a[80:83], a[108:111], a[156:159]
    v_mfma_f32_16x16x32_bf16 a[156:159], a[84:87], a[104:107], a[156:159]
    v_mfma_f32_16x16x32_bf16 a[156:159], a[88:91], a[100:103], a[156:159]
    v_mfma_f32_16x16x32_bf16 a[156:159], a[92:95], a[96:99], a[156:159]
    buffer_load_dwordx4 v[12:15], v254, s[24:27], 0 offen offset:3072
    s_nop 0
    s_waitcnt lgkmcnt(4)
    v_mfma_f32_16x16x32_bf16 a[128:131], a[0:3], a[32:35], a[128:131]
    ds_read2_b64 a[64:67], v237 offset0:40 offset1:41
    s_load_dword s71, s[44:45], s63
    v_mfma_f32_16x16x32_bf16 a[132:135], a[0:3], a[36:39], a[132:135]
    v_mfma_f32_16x16x32_bf16 a[132:135], a[4:7], a[32:35], a[132:135]
    ds_read_b128 a[96:99], v236 offset:128
    v_mfma_f32_16x16x32_bf16 a[136:139], a[0:3], a[40:43], a[136:139]
    v_mfma_f32_16x16x32_bf16 a[136:139], a[4:7], a[36:39], a[136:139]
    ds_read2_b64 a[68:71], v237 offset0:104 offset1:105
    v_mfma_f32_16x16x32_bf16 a[136:139], a[8:11], a[32:35], a[136:139]
    buffer_load_dwordx4 v[16:19], v254, s[24:27], s12 offen offset:0
    v_mfma_f32_16x16x32_bf16 a[140:143], a[0:3], a[44:47], a[140:143]
    ds_read_b128 a[100:103], v236 offset:640
    v_mfma_f32_16x16x32_bf16 a[140:143], a[4:7], a[40:43], a[140:143]
    v_mfma_f32_16x16x32_bf16 a[140:143], a[8:11], a[36:39], a[140:143]
    ds_read2_b64 a[72:75], v237 offset0:168 offset1:169
    v_mfma_f32_16x16x32_bf16 a[140:143], a[12:15], a[32:35], a[140:143]
    v_mfma_f32_16x16x32_bf16 a[144:147], a[0:3], a[48:51], a[144:147]
    ds_read_b128 a[104:107], v236 offset:1152
    v_mfma_f32_16x16x32_bf16 a[144:147], a[4:7], a[44:47], a[144:147]
    buffer_load_dwordx4 v[20:23], v254, s[24:27], s12 offen offset:3072
    v_mfma_f32_16x16x32_bf16 a[144:147], a[8:11], a[40:43], a[144:147]
    ds_read2_b64 a[76:79], v237 offset0:232 offset1:233
    v_mfma_f32_16x16x32_bf16 a[144:147], a[12:15], a[36:39], a[144:147]
    v_mfma_f32_16x16x32_bf16 a[144:147], a[16:19], a[32:35], a[144:147]
    ds_read_b128 a[108:111], v236 offset:1664
    v_mfma_f32_16x16x32_bf16 a[148:151], a[0:3], a[52:55], a[148:151]
    v_mfma_f32_16x16x32_bf16 a[148:151], a[4:7], a[48:51], a[148:151]
    ds_read2_b64 a[80:83], v239 offset0:40 offset1:41
    v_mfma_f32_16x16x32_bf16 a[148:151], a[8:11], a[44:47], a[148:151]
    buffer_load_dwordx4 v[24:27], v254, s[24:27], s13 offen offset:0
    v_mfma_f32_16x16x32_bf16 a[148:151], a[12:15], a[40:43], a[148:151]
    ds_read_b128 a[112:115], v236 offset:2176
    v_mfma_f32_16x16x32_bf16 a[148:151], a[16:19], a[36:39], a[148:151]
    v_mfma_f32_16x16x32_bf16 a[148:151], a[20:23], a[32:35], a[148:151]
    ds_read2_b64 a[84:87], v239 offset0:104 offset1:105
    s_nop 0
    s_waitcnt lgkmcnt(13)
    v_mfma_f32_16x16x32_bf16 a[152:155], a[0:3], a[56:59], a[152:155]
    v_mfma_f32_16x16x32_bf16 a[152:155], a[4:7], a[52:55], a[152:155]
    s_branch .Lover_1
.Lpad_1:
    s_setpc_b64 s[48:49]
.Lover_1:
    ds_read_b128 a[116:119], v236 offset:2688
    v_mfma_f32_16x16x32_bf16 a[152:155], a[8:11], a[48:51], a[152:155]
    buffer_load_dwordx4 v[28:31], v254, s[24:27], s13 offen offset:3072
    v_mfma_f32_16x16x32_bf16 a[152:155], a[12:15], a[44:47], a[152:155]
    ds_read2_b64 a[88:91], v239 offset0:168 offset1:169
    v_mfma_f32_16x16x32_bf16 a[152:155], a[16:19], a[40:43], a[152:155]
    v_mfma_f32_16x16x32_bf16 a[152:155], a[20:23], a[36:39], a[152:155]
    ds_read_b128 a[120:123], v236 offset:3200
    v_mfma_f32_16x16x32_bf16 a[152:155], a[24:27], a[32:35], a[152:155]
    s_nop 0
    s_waitcnt lgkmcnt(14)
    v_mfma_f32_16x16x32_bf16 a[156:159], a[0:3], a[60:63], a[156:159]
    ds_read2_b64 a[92:95], v239 offset0:232 offset1:233
    v_mfma_f32_16x16x32_bf16 a[156:159], a[4:7], a[56:59], a[156:159]
    buffer_load_dwordx4 v[32:35], v254, s[24:27], s14 offen offset:0
    v_mfma_f32_16x16x32_bf16 a[156:159], a[8:11], a[52:55], a[156:159]
    ds_read_b128 a[124:127], v236 offset:3712
    v_mfma_f32_16x16x32_bf16 a[156:159], a[12:15], a[48:51], a[156:159]
    v_mfma_f32_16x16x32_bf16 a[156:159], a[16:19], a[44:47], a[156:159]
    v_mfma_f32_16x16x32_bf16 a[156:159], a[20:23], a[40:43], a[156:159]
    v_mfma_f32_16x16x32_bf16 a[156:159], a[24:27], a[36:39], a[156:159]
    v_mfma_f32_16x16x32_bf16 a[156:159], a[28:31], a[32:35], a[156:159]
    buffer_load_dwordx4 v[36:39], v254, s[24:27], s14 offen offset:3072
    s_waitcnt lgkmcnt(0)
    s_mov_b32 s67, s71
    s_cmp_lt_u32 s67, 8
    s_cbranch_scc1 .Lslow_13
.Lback_14:
    v_mfma_f32_16x16x32_bf16 a[128:131], a[64:67], a[96:99], a[128:131]
    ds_read2_b64 a[0:3], v237 offset0:48 offset1:49
    v_mfma_f32_16x16x32_bf16 a[132:135], a[64:67], a[100:103], a[132:135]
    v_mfma_f32_16x16x32_bf16 a[132:135], a[68:71], a[96:99], a[132:135]
    ds_read_b128 a[32:35], v236 offset:64
    v_mfma_f32_16x16x32_bf16 a[136:139], a[64:67], a[104:107], a[136:139]
    v_mfma_f32_16x16x32_bf16 a[136:139], a[68:71], a[100:103], a[136:139]
    ds_read2_b64 a[4:7], v237 offset0:112 offset1:113
    v_mfma_f32_16x16x32_bf16 a[136:139], a[72:75], a[96:99], a[136:139]
    buffer_load_dwordx4 v[136:139], v244, s[44:47], s66 offen offset:0 sc1
    v_mfma_f32_16x16x32_bf16 a[140:143], a[64:67], a[108:111], a[140:143]
    ds_read_b128 a[36:39], v236 offset:576
    v_mfma_f32_16x16x32_bf16 a[140:143], a[68:71], a[104:107], a[140:143]
    v_mfma_f32_16x16x32_bf16 a[140:143], a[72:75], a[100:103], a[140:143]
    ds_read2_b64 a[8:11], v237 offset0:176 offset1:177
    v_mfma_f32_16x16x32_bf16 a[140:143], a[76:79], a[96:99], a[140:143]
    v_mfma_f32_16x16x32_bf16 a[144:147], a[64:67], a[112:115], a[144:147]
    ds_read_b128 a[40:43], v236 offset:1088
    buffer_load_dwordx4 v[152:155], v244, s[44:47], s64 offen offset:0 sc1
    v_mfma_f32_16x16x32_bf16 a[144:147], a[68:71], a[108:111], a[144:147]
    v_mfma_f32_16x16x32_bf16 a[144:147], a[72:75], a[104:107], a[144:147]
    ds_read2_b64 a[12:15], v237 offset0:240 offset1:241
    v_mfma_f32_16x16x32_bf16 a[144:147], a[76:79], a[100:103], a[144:147]
    v_mfma_f32_16x16x32_bf16 a[144:147], a[80:83], a[96:99], a[144:147]
    ds_read_b128 a[44:47], v236 offset:1600
    v_mfma_f32_16x16x32_bf16 a[148:151], a[64:67], a[116:119], a[148:151]
    buffer_load_dwordx4 v[140:143], v244, s[44:47], s66 offen offset:1024 sc1
    v_mfma_f32_16x16x32_bf16 a[148:151], a[68:71], a[112:115], a[148:151]
    ds_read2_b64 a[16:19], v239 offset0:48 offset1:49
    v_mfma_f32_16x16x32_bf16 a[148:151], a[72:75], a[108:111], a[148:151]
    v_mfma_f32_16x16x32_bf16 a[148:151], a[76:79], a[104:107], a[148:151]
    ds_read_b128 a[48:51], v236 offset:2112
    v_mfma_f32_16x16x32_bf16 a[148:151], a[80:83], a[100:103], a[148:151]
    v_mfma_f32_16x16x32_bf16 a[148:151], a[84:87], a[96:99], a[148:151]
    ds_read2_b64 a[20:23], v239 offset0:112 offset1:113
    buffer_load_dwordx4 v[156:159], v244, s[44:47], s64 offen offset:1024 sc1
    v_mfma_f32_16x16x32_bf16 a[152:155], a[64:67], a[120:123], a[152:155]
    v_mfma_f32_16x16x32_bf16 a[152:155], a[68:71], a[116:119], a[152:155]
    ds_read_b128 a[52:55], v236 offset:2624
    v_mfma_f32_16x16x32_bf16 a[152:155], a[72:75], a[112:115], a[152:155]
    v_mfma_f32_16x16x32_bf16 a[152:155], a[76:79], a[108:111], a[152:155]
    ds_read2_b64 a[24:27], v239 offset0:176 offset1:177
    v_mfma_f32_16x16x32_bf16 a[152:155], a[80:83], a[104:107], a[152:155]
    buffer_load_dwordx4 v[144:147], v244, s[44:47], s66 offen offset:2048 sc1
    v_mfma_f32_16x16x32_bf16 a[152:155], a[84:87], a[100:103], a[152:155]
    ds_read_b128 a[56:59], v236 offset:3136
    v_mfma_f32_16x16x32_bf16 a[152:155], a[88:91], a[96:99], a[152:155]
    v_mfma_f32_16x16x32_bf16 a[156:159], a[64:67], a[124:127], a[156:159]
    ds_read2_b64 a[28:31], v239 offset0:240 offset1:241
    v_mfma_f32_16x16x32_bf16 a[156:159], a[68:71], a[120:123], a[156:159]
    v_mfma_f32_16x16x32_bf16 a[156:159], a[72:75], a[116:119], a[156:159]
    ds_read_b128 a[60:63], v236 offset:3648
    buffer_load_dwordx4 v[160:163], v244, s[44:47], s64 offen offset:2048 sc1
    v_mfma_f32_16x16x32_bf16 a[156:159], a[76:79], a[112:115], a[156:159]
    v_mfma_f32_16x16x32_bf16 a[156:159], a[80:83], a[108:111], a[156:159]
    v_mfma_f32_16x16x32_bf16 a[156:159], a[84:87], a[104:107], a[156:159]
    v_mfma_f32_16x16x32_bf16 a[156:159], a[88:91], a[100:103], a[156:159]
    v_mfma_f32_16x16x32_bf16 a[156:159], a[92:95], a[96:99], a[156:159]
    buffer_load_dwordx4 v[148:151], v244, s[44:47], s66 offen offset:3072 sc1
    s_nop 0
    s_waitcnt lgkmcnt(4)
    v_mfma_f32_16x16x32_bf16 a[128:131], a[0:3], a[32:35], a[128:131]
    ds_read2_b64 a[64:67], v237 offset0:56 offset1:57
    v_mfma_f32_16x16x32_bf16 a[132:135], a[0:3], a[36:39], a[132:135]
    v_mfma_f32_16x16x32_bf16 a[132:135], a[4:7], a[32:35], a[132:135]
    ds_read_b128 a[96:99], v236 offset:0
    v_mfma_f32_16x16x32_bf16 a[136:139], a[0:3], a[40:43], a[136:139]
    v_mfma_f32_16x16x32_bf16 a[136:139], a[4:7], a[36:39], a[136:139]
    ds_read2_b64 a[68:71], v237 offset0:120 offset1:121
    v_mfma_f32_16x16x32_bf16 a[136:139], a[8:11], a[32:35], a[136:139]
    buffer_load_dwordx4 v[164:167], v244, s[44:47], s64 offen offset:3072 sc1
    v_mfma_f32_16x16x32_bf16 a[140:143], a[0:3], a[44:47], a[140:143]
    ds_read_b128 a[100:103], v236 offset:512
    v_mfma_f32_16x16x32_bf16 a[140:143], a[4:7], a[40:43], a[140:143]
    v_mfma_f32_16x16x32_bf16 a[140:143], a[8:11], a[36:39], a[140:143]
    ds_read2_b64 a[72:75], v237 offset0:184 offset1:185
    v_mfma_f32_16x16x32_bf16 a[140:143], a[12:15], a[32:35], a[140:143]
    v_mfma_f32_16x16x32_bf16 a[144:147], a[0:3], a[48:51], a[144:147]
    ds_read_b128 a[104:107], v236 offset:1024
    buffer_load_dwordx4 a[160:163], v252, s[44:47], s69 offen sc1
    v_mfma_f32_16x16x32_bf16 a[144:147], a[4:7], a[44:47], a[144:147]
    v_mfma_f32_16x16x32_bf16 a[144:147], a[8:11], a[40:43], a[144:147]
    ds_read2_b64 a[76:79], v237 offset0:248 offset1:249
    v_mfma_f32_16x16x32_bf16 a[144:147], a[12:15], a[36:39], a[144:147]
    v_mfma_f32_16x16x32_bf16 a[144:147], a[16:19], a[32:35], a[144:147]
    ds_read_b128 a[108:111], v236 offset:1536
    s_add_u32 s74, s69, 40960
    s_waitcnt vmcnt(8)
    v_lshlrev_b32 v168, 16, v136
    v_and_b32_e64 v169, s62, v136
    v_mfma_f32_16x16x32_bf16 a[148:151], a[0:3], a[52:55], a[148:151]
    buffer_load_dwordx4 a[164:167], v252, s[44:47], s74 offen sc1
    v_lshlrev_b32_e64 v170, 16, v137
    v_mfma_f32_16x16x32_bf16 a[148:151], a[4:7], a[48:51], a[148:151]
    ds_read2_b64 a[80:83], v239 offset0:56 offset1:57
    v_and_b32 v171, s62, v137
    v_mfma_f32_16x16x32_bf16 a[148:151], a[8:11], a[44:47], a[148:151]
    s_waitcnt vmcnt(8)
    v_fma_f32 v200, v168, v152, v153
    v_mfma_f32_16x16x32_bf16 a[148:151], a[12:15], a[40:43], a[148:151]
    ds_read_b128 a[112:115], v236 offset:2048
    v_fma_f32 v201, v169, v152, v153
    v_mfma_f32_16x16x32_bf16 a[148:151], a[16:19], a[36:39], a[148:151]
    s_add_u32 s69, s69, 4096
    s_sub_u32 s74, s69, 40960
    s_nop 0
    s_cselect_b32 s69, s69, s74
    v_fma_f32 v202, v170, v152, v153
    v_mfma_f32_16x16x32_bf16 a[148:151], a[20:23], a[32:35], a[148:151]
    ds_read2_b64 a[84:87], v239 offset0:120 offset1:121
    buffer_load_dwordx4 a[168:171], v252, s[44:47], s69 offen sc1
    v_fma_f32 v203, v171, v152, v153
    s_waitcnt lgkmcnt(13)
    v_mfma_f32_16x16x32_bf16 a[152:155], a[0:3], a[56:59], a[152:155]
    v_lshlrev_b32 v172, 16, v138
    v_mfma_f32_16x16x32_bf16 a[152:155], a[4:7], a[52:55], a[152:155]
    ds_read_b128 a[116:119], v236 offset:2560
    v_and_b32_e64 v173, s62, v138
    v_mfma_f32_16x16x32_bf16 a[152:155], a[8:11], a[48:51], a[152:155]
    v_lshlrev_b32 v174, 16, v139
    v_and_b32 v175, s62, v139
    v_mfma_f32_16x16x32_bf16 a[152:155], a[12:15], a[44:47], a[152:155]
    ds_read2_b64 a[88:91], v239 offset0:184 offset1:185
    s_add_u32 s74, s69, 40960
    v_fma_f32 v204, v172, v154, v155
    v_mfma_f32_16x16x32_bf16 a[152:155], a[16:19], a[40:43], a[152:155]
    buffer_load_dwordx4 a[172:175], v252, s[44:47], s74 offen sc1
    v_fma_f32 v205, v173, v154, v155
    v_mfma_f32_16x16x32_bf16 a[152:155], a[20:23], a[36:39], a[152:155]
    ds_read_b128 a[120:123], v236 offset:3072
    v_fma_f32 v206, v174, v154, v155
    v_mfma_f32_16x16x32_bf16 a[152:155], a[24:27], a[32:35], a[152:155]
    v_fma_f32 v207, v175, v154, v155
    s_waitcnt lgkmcnt(14)
    v_mfma_f32_16x16x32_bf16 a[156:159], a[0:3], a[60:63], a[156:159]
    ds_read2_b64 a[92:95], v239 offset0:248 offset1:249
    s_waitcnt vmcnt(9)
    v_lshlrev_b32_e64 v176, 16, v140
    v_mfma_f32_16x16x32_bf16 a[156:159], a[4:7], a[56:59], a[156:159]
    s_add_u32 s69, s69, 4096
    s_sub_u32 s74, s69, 40960
    s_cselect_b32 s69, s69, s74
    v_and_b32 v177, s62, v140
    v_mfma_f32_16x16x32_bf16 a[156:159], a[8:11], a[52:55], a[156:159]
    ds_read_b128 a[124:127], v236 offset:3584
    buffer_load_dwordx4 a[176:179], v252, s[44:47], s69 offen sc1
    v_lshlrev_b32_e64 v178, 16, v141
    v_mfma_f32_16x16x32_bf16 a[156:159], a[12:15], a[48:51], a[156:159]
    v_and_b32 v179, s62, v141
    v_mfma_f32_16x16x32_bf16 a[156:159], a[16:19], a[44:47], a[156:159]
    s_waitcnt vmcnt(9)
    v_fma_f32 v208, v176, v156, v157
    v_mfma_f32_16x16x32_bf16 a[156:159], a[20:23], a[40:43], a[156:159]
    v_fma_f32 v209, v177, v156, v157
    v_fma_f32 v210, v178, v156, v157
    v_mfma_f32_16x16x32_bf16 a[156:159], a[24:27], a[36:39], a[156:159]
    s_add_u32 s74, s69, 40960
    v_fma_f32 v211, v179, v156, v157
    v_mfma_f32_16x16x32_bf16 a[156:159], a[28:31], a[32:35], a[156:159]
    buffer_load_dwordx4 a[180:183], v252, s[44:47], s74 offen sc1
    v_lshlrev_b32 v180, 16, v142
    s_waitcnt lgkmcnt(1)
    v_mfma_f32_16x16x32_bf16 a[128:131], a[64:67], a[96:99], a[128:131]
    s_add_u32 s18, s63, 3072
    v_and_b32_e64 v181, s62, v142
    v_mfma_f32_16x16x32_bf16 a[132:135], a[64:67], a[100:103], a[132:135]
    v_lshlrev_b32_e64 v182, 16, v143
    v_mfma_f32_16x16x32_bf16 a[132:135], a[68:71], a[96:99], a[132:135]
    v_and_b32_e64 v183, s62, v143
    v_mfma_f32_16x16x32_bf16 a[136:139], a[64:67], a[104:107], a[136:139]
    v_fma_f32 v212, v180, v158, v159
    v_mfma_f32_16x16x32_bf16 a[136:139], a[68:71], a[100:103], a[136:139]
    s_add_u32 s69, s69, 4096
    s_sub_u32 s74, s69, 40960
    s_nop 0
    s_cselect_b32 s69, s69, s74
    v_fma_f32 v213, v181, v158, v159
    v_mfma_f32_16x16x32_bf16 a[136:139], a[72:75], a[96:99], a[136:139]
    buffer_load_dwordx4 a[184:187], v252, s[44:47], s69 offen sc1
    v_fma_f32 v214, v182, v158, v159
    v_mfma_f32_16x16x32_bf16 a[140:143], a[64:67], a[108:111], a[140:143]
    ds_write_b128 v235, a[128:131] offset:16384
    v_fma_f32 v215, v183, v158, v159
    v_mfma_f32_16x16x32_bf16 a[140:143], a[68:71], a[104:107], a[140:143]
    s_waitcnt vmcnt(10)
    v_lshlrev_b32 v184, 16, v144
    v_and_b32_e64 v185, s62, v144
    v_mfma_f32_16x16x32_bf16 a[140:143], a[72:75], a[100:103], a[140:143]
    v_lshlrev_b32_e64 v186, 16, v145
    v_mfma_f32_16x16x32_bf16 a[140:143], a[76:79], a[96:99], a[140:143]
    v_and_b32 v187, s62, v145
    v_mfma_f32_16x16x32_bf16 a[144:147], a[64:67], a[112:115], a[144:147]
    ds_write_b128 v235, a[132:135] offset:17408
    s_add_u32 s74, s69, 40960
    s_waitcnt vmcnt(9)
    v_fma_f32 v216, v184, v160, v161
    v_mfma_f32_16x16x32_bf16 a[144:147], a[68:71], a[108:111], a[144:147]
    buffer_load_dwordx4 a[188:191], v252, s[44:47], s74 offen sc1
    v_fma_f32 v217, v185, v160, v161
    v_mfma_f32_16x16x32_bf16 a[144:147], a[72:75], a[104:107], a[144:147]
    v_fma_f32 v218, v186, v160, v161
    v_mfma_f32_16x16x32_bf16 a[144:147], a[76:79], a[100:103], a[144:147]
    v_fma_f32 v219, v187, v160, v161
    v_mfma_f32_16x16x32_bf16 a[144:147], a[80:83], a[96:99], a[144:147]
    ds_write_b128 v235, a[136:139] offset:18432
    v_lshlrev_b32_e64 v188, 16, v146
    v_mfma_f32_16x16x32_bf16 a[148:151], a[64:67], a[116:119], a[148:151]
    v_and_b32_e64 v189, s62, v146
    v_mfma_f32_16x16x32_bf16 a[148:151], a[68:71], a[112:115], a[148:151]
    s_add_u32 s69, s69, 4096
    s_sub_u32 s74, s69, 40960
    s_cselect_b32 s69, s69, s74
    v_lshlrev_b32 v190, 16, v147
    v_and_b32_e64 v191, s62, v147
    v_mfma_f32_16x16x32_bf16 a[148:151], a[72:75], a[108:111], a[148:151]
    buffer_load_dwordx4 a[192:195], v252, s[44:47], s69 offen sc1
    v_fma_f32 v220, v188, v162, v163
    v_mfma_f32_16x16x32_bf16 a[148:151], a[76:79], a[104:107], a[148:151]
    ds_write_b128 v235, a[140:143] offset:19456
    v_fma_f32 v221, v189, v162, v163
    v_mfma_f32_16x16x32_bf16 a[148:151], a[80:83], a[100:103], a[148:151]
    v_fma_f32 v222, v190, v162, v163
    v_mfma_f32_16x16x32_bf16 a[148:151], a[84:87], a[96:99], a[148:151]
    v_fma_f32 v223, v191, v162, v163
    v_mfma_f32_16x16x32_bf16 a[152:155], a[64:67], a[120:123], a[152:155]
    s_waitcnt vmcnt(10)
    v_lshlrev_b32 v192, 16, v148
    v_mfma_f32_16x16x32_bf16 a[152:155], a[68:71], a[116:119], a[152:155]
    ds_write_b128 v235, a[144:147] offset:20480
    s_add_u32 s74, s69, 40960
    v_and_b32_e64 v193, s62, v148
    v_mfma_f32_16x16x32_bf16 a[152:155], a[72:75], a[112:115], a[152:155]
    buffer_load_dwordx4 a[196:199], v252, s[44:47], s74 offen sc1
    v_lshlrev_b32_e64 v194, 16, v149
    v_mfma_f32_16x16x32_bf16 a[152:155], a[76:79], a[108:111], a[152:155]
    v_and_b32 v195, s62, v149
    v_mfma_f32_16x16x32_bf16 a[152:155], a[80:83], a[104:107], a[152:155]
    s_waitcnt vmcnt(10)
    v_fma_f32 v224, v192, v164, v165
    v_mfma_f32_16x16x32_bf16 a[152:155], a[84:87], a[100:103], a[152:155]
    ds_write_b128 v235, a[148:151] offset:21504
    v_fma_f32 v225, v193, v164, v165
    v_fma_f32 v226, v194, v164, v165
    v_mfma_f32_16x16x32_bf16 a[152:155], a[88:91], a[96:99], a[152:155]
    v_fma_f32 v227, v195, v164, v165
    s_nop 0
    s_waitcnt lgkmcnt(6)
    v_mfma_f32_16x16x32_bf16 a[156:159], a[64:67], a[124:127], a[156:159]
    s_add_u32 s69, s69, 4096
    s_sub_u32 s74, s69, 40960
    s_cselect_b32 s69, s69, s74
    v_lshlrev_b32 v196, 16, v150
    v_mfma_f32_16x16x32_bf16 a[156:159], a[68:71], a[120:123], a[156:159]
    buffer_load_dwordx4 a[200:203], v252, s[44:47], s69 offen sc1
    v_and_b32_e64 v197, s62, v150
    v_mfma_f32_16x16x32_bf16 a[156:159], a[72:75], a[116:119], a[156:159]
    v_lshlrev_b32_e64 v198, 16, v151
    v_mfma_f32_16x16x32_bf16 a[156:159], a[76:79], a[112:115], a[156:159]
    v_and_b32_e64 v199, s62, v151
    v_mfma_f32_16x16x32_bf16 a[156:159], a[80:83], a[108:111], a[156:159]
    ds_write_b128 v235, a[152:155] offset:22528
    v_fma_f32 v228, v196, v166, v167
    v_mfma_f32_16x16x32_bf16 a[156:159], a[84:87], a[104:107], a[156:159]
    v_fma_f32 v229, v197, v166, v167
    v_mfma_f32_16x16x32_bf16 a[156:159], a[88:91], a[100:103], a[156:159]
    s_add_u32 s74, s69, 40960
    v_fma_f32 v230, v198, v166, v167
    v_mfma_f32_16x16x32_bf16 a[156:159], a[92:95], a[96:99], a[156:159]
    buffer_load_dwordx4 a[204:207], v252, s[44:47], s74 offen sc1
    v_fma_f32 v231, v199, v166, v167
    s_nop 0
    s_nop 5
    ds_write_b128 v235, a[156:159] offset:23552
    s_waitcnt lgkmcnt(0)
    s_barrier
    ds_read_b128 v[136:139], v238 offset:0
    ds_read_b128 v[140:143], v238 offset:40960
    ds_read_b128 v[144:147], v247 offset:0
    ds_read_b128 v[148:151], v247 offset:40960
    ds_read_b128 v[152:155], v238 offset:1024
    ds_read_b128 v[156:159], v238 offset:41984
    ds_read_b128 v[160:163], v247 offset:1024
    ds_read_b128 v[164:167], v247 offset:41984
    s_waitcnt lgkmcnt(7)
    v_fmac_f32 v168, v200, v136
    s_waitcnt lgkmcnt(6)
    v_fmac_f32 v169, v201, v140
    s_waitcnt lgkmcnt(5)
    v_fmac_f32 v170, v202, v144
    s_waitcnt lgkmcnt(4)
    v_fmac_f32 v171, v203, v148
    v_cvt_pk_bf16_f32 v200, v168, v169
    v_cvt_pk_bf16_f32 v201, v170, v171
    v_fmac_f32 v172, v204, v137
    v_fmac_f32 v173, v205, v141
    v_fmac_f32 v174, v206, v145
    v_fmac_f32 v175, v207, v149
    v_cvt_pk_bf16_f32 v202, v172, v173
    v_cvt_pk_bf16_f32 v203, v174, v175
    buffer_store_dwordx4 v[200:203], v245, s[44:47], 0 offen offset:0 sc1
    v_fmac_f32 v176, v208, v138
    v_fmac_f32 v177, v209, v142
    v_fmac_f32 v178, v210, v146
    v_fmac_f32 v179, v211, v150
    v_cvt_pk_bf16_f32 v208, v176, v177
    v_cvt_pk_bf16_f32 v209, v178, v179
    v_fmac_f32 v180, v212, v139
    v_fmac_f32 v181, v213, v143
    v_fmac_f32 v182, v214, v147
    v_fmac_f32 v183, v215, v151
    v_cvt_pk_bf16_f32 v210, v180, v181
    v_cvt_pk_bf16_f32 v211, v182, v183
    buffer_store_dwordx4 v[208:211], v245, s[44:47], 0 offen offset:1024 sc1
    s_waitcnt lgkmcnt(3)
    v_fmac_f32 v184, v216, v152
    s_waitcnt lgkmcnt(2)
    v_fmac_f32 v185, v217, v156
    s_waitcnt lgkmcnt(1)
    v_fmac_f32 v186, v218, v160
    s_waitcnt lgkmcnt(0)
    v_fmac_f32 v187, v219, v164
    v_cvt_pk_bf16_f32 v216, v184, v185
    v_cvt_pk_bf16_f32 v217, v186, v187
    v_fmac_f32 v188, v220, v153
    v_fmac_f32 v189, v221, v157
    v_fmac_f32 v190, v222, v161
    v_fmac_f32 v191, v223, v165
    v_cvt_pk_bf16_f32 v218, v188, v189
    v_cvt_pk_bf16_f32 v219, v190, v191
    buffer_store_dwordx4 v[216:219], v245, s[44:47], 0 offen offset:2048 sc1
    v_fmac_f32 v192, v224, v154
    v_fmac_f32 v193, v225, v158
    v_fmac_f32 v194, v226, v162
    v_fmac_f32 v195, v227, v166
    v_cvt_pk_bf16_f32 v224, v192, v193
    v_cvt_pk_bf16_f32 v225, v194, v195
    v_fmac_f32 v196, v228, v155
    v_fmac_f32 v197, v229, v159
    v_fmac_f32 v198, v230, v163
    v_fmac_f32 v199, v231, v167
    v_cvt_pk_bf16_f32 v226, v196, v197
    v_cvt_pk_bf16_f32 v227, v198, v199
    buffer_store_dwordx4 v[224:227], v245, s[44:47], 0 offen offset:3072 sc1
    v_perm_b32 v200, v44, v40, s16
    v_perm_b32 v201, v52, v48, s16
    v_perm_b32 v202, v60, v56, s16
    v_perm_b32 v203, v68, v64, s16
    ds_write_b128 v232, v[200:203] offset:8192
    s_and_b32 s60, s51, 7
    s_lshl2_add_u32 s60, s60, s3
    s_mul_i32 s60, s60, 61440
    v_lshl_add_u32 v247, v0, 4, s60
    v_add_u32 v255, 0x1000, v247
    v_lshlrev_b32 v4, 4, v0
    v_xor_b32 v250, 16, v4
    v_perm_b32 v204, v44, v40, s17
    v_perm_b32 v205, v52, v48, s17
    v_perm_b32 v206, v60, v56, s17
    v_perm_b32 v207, v68, v64, s17
    ds_write_b128 v233, v[204:207] offset:8192
    v_add_u32 v5, 40960, v250
    v_xor_b32_e64 v250, 32, v4
    v_add_u32 v6, 81920, v250
    v_xor_b32 v250, 48, v4
    v_add_u32 v7, 122880, v250
    v_lshl_add_u32 v253, s3, 10, v5
    s_lshl2_add_u32 s60, s55, s3
    v_perm_b32 v208, v45, v41, s16
    v_perm_b32 v209, v53, v49, s16
    v_perm_b32 v210, v61, v57, s16
    v_perm_b32 v211, v69, v65, s16
    ds_write_b128 v234, v[208:211] offset:8192
    s_lshl_b32 s61, s60, 8
    v_and_b32 v250, 15, v0
    v_lshlrev_b32 v3, 4, v250
    v_add_u32 v250, s61, v3
    v_lshrrev_b32_e64 v249, 4, v0
    s_mov_b32 s61, 16384
    v_mad_u32_u24 v1, v249, s61, v250
    v_perm_b32 v212, v45, v41, s17
    v_perm_b32 v213, v53, v49, s17
    v_perm_b32 v214, v61, v57, s17
    v_perm_b32 v215, v69, v65, s17
    ds_write_b128 v243, v[212:215] offset:8192
    v_lshl_add_u32 v3, v249, 9, v3
    s_and_b32 s64, s60, 7
    s_mul_i32 s61, s64, 196608
    s_bfe_u32 s64, s60, 0x20003
    s_lshl_b32 s64, s64, 22
    s_add_u32 s61, s61, s64
    s_lshr_b32 s64, s60, 5
    v_perm_b32 v200, v46, v42, s16
    v_perm_b32 v201, v54, v50, s16
    v_perm_b32 v202, v62, v58, s16
    v_perm_b32 v203, v70, v66, s16
    ds_write_b128 v232, v[200:203] offset:8448
    s_lshl_b32 s64, s64, 13
    s_add_u32 s61, s61, s64
    v_lshl_add_u32 v2, v0, 4, s61
    s_lshr_b32 s54, s60, 1
    s_and_b32 s64, s54, 16
    s_mul_i32 s64, s64, 3
    s_add_u32 s54, s54, s64
    s_load_dword s71, s[44:45], s18
    v_perm_b32 v204, v46, v42, s17
    v_perm_b32 v205, v54, v50, s17
    v_perm_b32 v206, v62, v58, s17
    v_perm_b32 v207, v70, v66, s17
    ds_write_b128 v233, v[204:207] offset:8448
    s_lshl_b32 s54, s54, 7
    s_add_u32 s54, s54, 16384
    s_lshr_b32 s61, s51, 3
    s_lshl2_add_u32 s53, s50, s61
    s_lshl_b32 s52, s53, 1
    s_and_b32 s64, s53, 16
    s_mul_i32 s64, s64, 3
    s_add_u32 s69, s69, 4096
    s_sub_u32 s74, s69, 40960
    s_nop 0
    s_cselect_b32 s69, s69, s74
    buffer_load_dwordx4 a[208:211], v252, s[44:47], s69 offen sc1
    v_perm_b32 v208, v47, v43, s16
    v_perm_b32 v209, v55, v51, s16
    v_perm_b32 v210, v63, v59, s16
    v_perm_b32 v211, v71, v67, s16
    ds_write_b128 v234, v[208:211] offset:8448
    s_add_u32 s53, s53, s64
    s_lshl_b32 s53, s53, 7
    s_add_u32 s53, s53, 16384
    s_add_u32 s60, s59, 0
    s_and_b32 s60, s60, 3
    s_mul_i32 s61, s60, 655360
    s_add_u32 s61, s61, 16777216
    s_add_u32 s74, s69, 40960
    buffer_load_dwordx4 a[212:215], v252, s[44:47], s74 offen sc1
    s_add_u32 s69, s69, 4096
    s_sub_u32 s74, s69, 40960
    s_nop 0
    s_cselect_b32 s69, s69, s74
    buffer_load_dwordx4 a[216:219], v252, s[44:47], s69 offen sc1
    v_perm_b32 v212, v47, v43, s17
    v_perm_b32 v213, v55, v51, s17
    v_perm_b32 v214, v63, v59, s17
    v_perm_b32 v215, v71, v67, s17
    ds_write_b128 v243, v[212:215] offset:8448
    s_nop 0
    s_cmp_lt_u32 s60, 3
    s_cselect_b32 s4, s61, 9437184
    s_add_u32 s60, s59, 1
    s_and_b32 s60, s60, 3
    s_mul_i32 s61, s60, 655360
    s_add_u32 s61, s61, 16777216
    s_cmp_lt_u32 s60, 3
    s_cselect_b32 s5, s61, 9437184
    s_add_u32 s60, s59, 2
    s_add_u32 s74, s69, 40960
    buffer_load_dwordx4 a[220:223], v252, s[44:47], s74 offen sc1
    v_perm_b32 v200, v76, v72, s16
    v_perm_b32 v201, v84, v80, s16
    v_perm_b32 v202, v92, v88, s16
    v_perm_b32 v203, v100, v96, s16
    ds_write_b128 v232, v[200:203] offset:16384
    s_and_b32 s60, s60, 3
    s_mul_i32 s61, s60, 655360
    s_add_u32 s61, s61, 16777216
    s_cmp_lt_u32 s60, 3
    s_cselect_b32 s6, s61, 9437184
    s_add_u32 s60, s59, 3
    s_and_b32 s60, s60, 3
    s_mul_i32 s61, s60, 655360
    s_add_u32 s69, s69, 4096
    s_sub_u32 s74, s69, 40960
    s_nop 0
    s_cselect_b32 s69, s69, s74
    buffer_load_dwordx4 a[224:227], v252, s[44:47], s69 offen sc1
    s_add_u32 s74, s69, 40960
    buffer_load_dwordx4 a[228:231], v252, s[44:47], s74 offen sc1
    v_perm_b32 v204, v76, v72, s17
    v_perm_b32 v205, v84, v80, s17
    v_perm_b32 v206, v92, v88, s17
    v_perm_b32 v207, v100, v96, s17
    ds_write_b128 v233, v[204:207] offset:16384
    s_add_u32 s61, s61, 16777216
    s_cmp_lt_u32 s60, 3
    s_cselect_b32 s7, s61, 9437184
    v_and_b32 v250, 3, v0
    v_bfe_u32 v249, v0, 2, 1
    v_lshl_add_u32 v250, v249, 3, v250
    v_bfe_u32 v249, v0, 4, 1
    v_lshl_add_u32 v250, v249, 2, v250
    s_add_u32 s69, s69, 4096
    s_sub_u32 s74, s69, 40960
    s_cselect_b32 s69, s69, s74
    buffer_load_dwordx4 a[232:235], v252, s[44:47], s69 offen sc1
    s_add_u32 s74, s69, 40960
    buffer_load_dwordx4 a[236:239], v252, s[44:47], s74 offen sc1
    s_waitcnt lgkmcnt(0)
    s_waitcnt vmcnt(8)
    s_barrier
    s_mov_b32 s23, 1
    s_cmp_lg_u32 s3, 0
    s_cbranch_scc1 .Lnoarr_15
    s_atomic_add s23, s[44:45], s1 offset:5120 glc
.Lnoarr_15:
    s_mov_b32 s67, s71
    s_cmp_lt_u32 s67, 8
    s_cbranch_scc1 .Lslow_16
.Lback_17:
    v_perm_b32 v208, v77, v73, s16
    v_perm_b32 v209, v85, v81, s16
    v_perm_b32 v210, v93, v89, s16
    v_perm_b32 v211, v101, v97, s16
    ds_write_b128 v234, v[208:211] offset:16384
    v_lshlrev_b32 v250, 4, v250
    v_bfe_u32 v249, v0, 3, 1
    s_movk_i32 s61, 12288
    v_mad_u32_u24 v246, v249, s61, v250
    s_mov_b32 s72, 0x3f803f80
    s_mov_b32 s75, 1
    s_lshl_b32 s62, s57, 7
    s_mov_b32 s68, 2097152
    buffer_load_dwordx4 a[0:3], v247, s[44:47], s68 offen offset:0 sc1
    v_perm_b32 v212, v77, v73, s17
    v_perm_b32 v213, v85, v81, s17
    v_perm_b32 v214, v93, v89, s17
    v_perm_b32 v215, v101, v97, s17
    ds_write_b128 v243, v[212:215] offset:16384
    s_add_u32 s62, s62, 65536
    s_lshl_b32 s63, s58, 7
    s_add_u32 s63, s63, 65536
    s_and_b32 s60, s57, -8
    s_add_u32 s57, s57, s60
    s_lshl_b32 s57, s57, 10
    s_add_u32 s57, s57, 20971520
    buffer_load_dwordx4 a[4:7], v247, s[44:47], s68 offen offset:1024 sc1
    buffer_load_dwordx4 a[8:11], v247, s[44:47], s68 offen offset:2048 sc1
    v_perm_b32 v200, v78, v74, s16
    v_perm_b32 v201, v86, v82, s16
    v_perm_b32 v202, v94, v90, s16
    v_perm_b32 v203, v102, v98, s16
    ds_write_b128 v232, v[200:203] offset:16640
    s_and_b32 s60, s58, -8
    s_add_u32 s58, s58, s60
    s_lshl_b32 s58, s58, 10
    s_add_u32 s58, s58, 20971520
    s_and_b32 s64, s52, 7
    s_mul_i32 s66, s64, 196608
    s_bfe_u32 s64, s52, 0x20003
    buffer_load_dwordx4 a[12:15], v247, s[44:47], s68 offen offset:3072 sc1
    buffer_load_dwordx4 a[16:19], v255, s[44:47], s68 offen offset:0 sc1
    v_perm_b32 v204, v78, v74, s17
    v_perm_b32 v205, v86, v82, s17
    v_perm_b32 v206, v94, v90, s17
    v_perm_b32 v207, v102, v98, s17
    ds_write_b128 v233, v[204:207] offset:16640
    s_lshl_b32 s64, s64, 22
    s_add_u32 s66, s66, s64
    s_lshr_b32 s64, s52, 5
    s_lshl_b32 s64, s64, 13
    s_add_u32 s66, s66, s64
    s_mul_i32 s65, s3, 49152
    s_add_u32 s65, s65, s66
    s_mov_b32 s68, 2117632
    buffer_load_dwordx4 a[20:23], v247, s[44:47], s68 offen offset:0 sc1
    v_perm_b32 v208, v79, v75, s16
    v_perm_b32 v209, v87, v83, s16
    v_perm_b32 v210, v95, v91, s16
    v_perm_b32 v211, v103, v99, s16
    ds_write_b128 v234, v[208:211] offset:16640
    s_xor_b32 s60, s3, 0
    s_lshr_b32 s61, s60, 1
    s_mul_i32 s61, s61, 196608
    s_branch .Lover_2
.Lpad_2:
    s_setpc_b64 s[48:49]
.Lover_2:
    s_and_b32 s60, s60, 1
    s_lshl_b32 s60, s60, 8
    s_add_u32 s60, s60, s65
    s_add_u32 s8, s61, s60
    buffer_load_dwordx4 a[24:27], v247, s[44:47], s68 offen offset:1024 sc1
    buffer_load_dwordx4 a[28:31], v247, s[44:47], s68 offen offset:2048 sc1
    v_perm_b32 v212, v79, v75, s17
    v_perm_b32 v213, v87, v83, s17
    v_perm_b32 v214, v95, v91, s17
    v_perm_b32 v215, v103, v99, s17
    ds_write_b128 v243, v[212:215] offset:16640
    s_xor_b32 s60, s3, 1
    s_lshr_b32 s61, s60, 1
    s_mul_i32 s61, s61, 196608
    s_and_b32 s60, s60, 1
    s_lshl_b32 s60, s60, 8
    s_add_u32 s60, s60, s65
    s_add_u32 s9, s61, s60
    buffer_load_dwordx4 a[32:35], v247, s[44:47], s68 offen offset:3072 sc1
    buffer_load_dwordx4 a[36:39], v255, s[44:47], s68 offen offset:0 sc1
    s_waitcnt lgkmcnt(0)
    s_cmp_lg_u32 s23, 31
    s_cbranch_scc1 .Lnotlast_18
    s_mov_b32 exec_lo, 15
    s_mov_b32 exec_hi, 15
    v_lshlrev_b32 v242, 8, v0
    s_mov_b32 s67, 6144
    buffer_atomic_add v248, v242, s[44:47], s67 offen sc1
    s_nop 0
    s_mov_b64 exec, -1
.Lnotlast_18:
    v_perm_b32 v200, v108, v104, s16
    v_perm_b32 v201, v116, v112, s16
    v_perm_b32 v202, v124, v120, s16
    v_perm_b32 v203, v132, v128, s16
    ds_write_b128 v232, v[200:203] offset:24576
    s_xor_b32 s60, s3, 2
    s_lshr_b32 s61, s60, 1
    s_mul_i32 s61, s61, 196608
    s_and_b32 s60, s60, 1
    s_lshl_b32 s60, s60, 8
    s_add_u32 s60, s60, s65
    s_add_u32 s10, s61, s60
    v_perm_b32 v204, v108, v104, s17
    v_perm_b32 v205, v116, v112, s17
    v_perm_b32 v206, v124, v120, s17
    v_perm_b32 v207, v132, v128, s17
    ds_write_b128 v233, v[204:207] offset:24576
    s_xor_b32 s60, s3, 3
    s_lshr_b32 s61, s60, 1
    s_mul_i32 s61, s61, 196608
    s_and_b32 s60, s60, 1
    s_lshl_b32 s60, s60, 8
    s_add_u32 s60, s60, s65
    s_add_u32 s11, s61, s60
    s_mov_b32 s68, 2127872
    buffer_load_dwordx4 a[40:43], v247, s[44:47], s68 offen offset:0 sc1
    v_perm_b32 v208, v109, v105, s16
    v_perm_b32 v209, v117, v113, s16
    v_perm_b32 v210, v125, v121, s16
    v_perm_b32 v211, v133, v129, s16
    ds_write_b128 v234, v[208:211] offset:24576
    s_lshr_b32 s60, s3, 1
    s_add_u32 s60, s60, s52
    s_lshl_b32 s20, s60, 8
    s_and_b32 s64, s3, 1
    s_lshl3_add_u32 s20, s64, s20
    s_and_b32 s65, s51, 7
    s_mul_i32 s66, s65, 327680
    v_perm_b32 v212, v109, v105, s17
    v_perm_b32 v213, v117, v113, s17
    v_perm_b32 v214, v125, v121, s17
    v_perm_b32 v215, v133, v129, s17
    ds_write_b128 v243, v[212:215] offset:24576
    s_add_u32 s20, s20, s66
    s_mov_b32 s66, 16777216
    s_cmp_lt_u32 s65, 6
    s_cselect_b32 s66, s66, 7471104
    s_nop 0
    s_add_u32 s20, s20, s66
    s_mov_b32 s22, 16384
    s_lshr_b32 s21, s52, 3
    s_lshl_b32 s21, s21, 8
    buffer_load_dwordx4 a[44:47], v247, s[44:47], s68 offen offset:1024 sc1
    v_perm_b32 v200, v110, v106, s16
    v_perm_b32 v201, v118, v114, s16
    v_perm_b32 v202, v126, v122, s16
    v_perm_b32 v203, v134, v130, s16
    ds_write_b128 v232, v[200:203] offset:24832
    s_and_b32 s66, s60, 3
    s_lshl2_add_u32 s21, s66, s21
    s_bfe_u32 s66, s52, 0x10002
    s_lshl1_add_u32 s21, s66, s21
    s_add_u32 s21, s21, s64
    s_mul_i32 s21, s21, 1280
    s_mul_i32 s66, s65, 160
    buffer_load_dwordx4 a[48:51], v247, s[44:47], s68 offen offset:2048 sc1
    v_perm_b32 v204, v110, v106, s17
    v_perm_b32 v205, v118, v114, s17
    v_perm_b32 v206, v126, v122, s17
    v_perm_b32 v207, v134, v130, s17
    ds_write_b128 v233, v[204:207] offset:24832
    s_add_u32 s21, s21, s66
    s_lshl_b32 s73, s56, 8
    s_add_u32 s73, s73, 131072
    s_and_b32 s56, s56, 3
    s_mul_i32 s56, s56, 10
    v_perm_b32 v208, v111, v107, s16
    v_perm_b32 v209, v119, v115, s16
    v_perm_b32 v210, v127, v123, s16
    v_perm_b32 v211, v135, v131, s16
    ds_write_b128 v234, v[208:211] offset:24832
    buffer_load_dwordx4 a[52:55], v247, s[44:47], s68 offen offset:3072 sc1
    v_perm_b32 v212, v111, v107, s17
    v_perm_b32 v213, v119, v115, s17
    v_perm_b32 v214, v127, v123, s17
    v_perm_b32 v215, v135, v131, s17
    ds_write_b128 v243, v[212:215] offset:24832
    buffer_load_dwordx4 a[56:59], v255, s[44:47], s68 offen offset:0 sc1
    v_perm_b32 v200, v12, v8, s16
    v_perm_b32 v201, v20, v16, s16
    v_perm_b32 v202, v28, v24, s16
    v_perm_b32 v203, v36, v32, s16
    ds_write_b128 v232, v[200:203] offset:32768
    v_perm_b32 v204, v12, v8, s17
    v_perm_b32 v205, v20, v16, s17
    v_perm_b32 v206, v28, v24, s17
    v_perm_b32 v207, v36, v32, s17
    ds_write_b128 v233, v[204:207] offset:32768
    s_mov_b32 s68, 2148352
    buffer_load_dwordx4 a[60:63], v247, s[44:47], s68 offen offset:0 sc1
    v_perm_b32 v208, v13, v9, s16
    v_perm_b32 v209, v21, v17, s16
    v_perm_b32 v210, v29, v25, s16
    v_perm_b32 v211, v37, v33, s16
    ds_write_b128 v234, v[208:211] offset:32768
    v_perm_b32 v212, v13, v9, s17
    v_perm_b32 v213, v21, v17, s17
    v_perm_b32 v214, v29, v25, s17
    v_perm_b32 v215, v37, v33, s17
    ds_write_b128 v243, v[212:215] offset:32768
    buffer_load_dwordx4 a[64:67], v247, s[44:47], s68 offen offset:1024 sc1
    v_perm_b32 v200, v14, v10, s16
    v_perm_b32 v201, v22, v18, s16
    v_perm_b32 v202, v30, v26, s16
    v_perm_b32 v203, v38, v34, s16
    ds_write_b128 v232, v[200:203] offset:33024
    buffer_load_dwordx4 a[68:71], v247, s[44:47], s68 offen offset:2048 sc1
    v_perm_b32 v204, v14, v10, s17
    v_perm_b32 v205, v22, v18, s17
    v_perm_b32 v206, v30, v26, s17
    v_perm_b32 v207, v38, v34, s17
    ds_write_b128 v233, v[204:207] offset:33024
    v_perm_b32 v208, v15, v11, s16
    v_perm_b32 v209, v23, v19, s16
    v_perm_b32 v210, v31, v27, s16
    v_perm_b32 v211, v39, v35, s16
    ds_write_b128 v234, v[208:211] offset:33024
    buffer_load_dwordx4 a[72:75], v247, s[44:47], s68 offen offset:3072 sc1
    v_perm_b32 v212, v15, v11, s17
    v_perm_b32 v213, v23, v19, s17
    v_perm_b32 v214, v31, v27, s17
    v_perm_b32 v215, v39, v35, s17
    ds_write_b128 v243, v[212:215] offset:33024
    buffer_load_dwordx4 a[76:79], v255, s[44:47], s68 offen offset:0 sc1
    v_lshl_add_u32 v252, s3, 10, v4
    s_mov_b32 s74, 131072
.Ljoin:
    s_add_u32 s60, s1, 6144
    s_cmp_lg_u32 s3, 0
    s_cbranch_scc1 .Lnw0_19
    s_mov_b64 exec, 1
    s_load_dword s71, s[44:45], s60
    s_waitcnt lgkmcnt(0)
    s_cmp_ge_u32 s71, 8
    s_cbranch_scc1 .Lpassed_20
    s_mov_b32 s70, 100000
.Lspin_21:
    buffer_load_dword v250, off, s[44:47], s60 sc1
    s_waitcnt vmcnt(0)
    v_readfirstlane_b32 s67, v250
    s_sub_u32 s70, s70, 1
    s_cbranch_scc1 .Ldone_22
    s_cmp_lt_u32 s67, 8
    s_cbranch_scc1 .Lspin_21
.Ldone_22:
.Lpassed_20:
    s_mov_b64 exec, -1
.Lnw0_19:
    s_waitcnt lgkmcnt(0)
    s_nop 0
    s_barrier
    buffer_load_dwordx4 v[8:11], v1, s[44:47], s4 offen sc1
    s_add_u32 s61, s4, 65536
    buffer_load_dwordx4 v[12:15], v1, s[44:47], s61 offen sc1
    s_add_u32 s61, s4, 131072
    buffer_load_dwordx4 v[16:19], v1, s[44:47], s61 offen sc1
    s_add_u32 s61, s4, 196608
    buffer_load_dwordx4 v[20:23], v1, s[44:47], s61 offen sc1
    s_add_u32 s61, s4, 262144
    buffer_load_dwordx4 v[24:27], v1, s[44:47], s61 offen sc1
    s_add_u32 s61, s4, 327680
    buffer_load_dwordx4 v[28:31], v1, s[44:47], s61 offen sc1
    s_add_u32 s61, s4, 393216
    buffer_load_dwordx4 v[32:35], v1, s[44:47], s61 offen sc1
    s_add_u32 s61, s4, 458752
    buffer_load_dwordx4 v[36:39], v1, s[44:47], s61 offen sc1
    s_add_u32 s61, s4, 524288
    buffer_load_dwordx4 v[40:43], v1, s[44:47], s61 offen sc1
    s_add_u32 s61, s4, 589824
    buffer_load_dwordx4 v[44:47], v1, s[44:47], s61 offen sc1
    buffer_load_dwordx4 v[48:51], v1, s[44:47], s5 offen sc1
    s_add_u32 s61, s5, 65536
    buffer_load_dwordx4 v[52:55], v1, s[44:47], s61 offen sc1
    ds_read_b128 a[124:127], v4 offset:0
    ds_read_b128 a[128:131], v5 offset:0
    ds_read_b128 a[132:135], v6 offset:0
    ds_read_b128 a[136:139], v4 offset:1024
    ds_read_b128 a[140:143], v5 offset:1024
    ds_read_b128 a[144:147], v6 offset:1024
    s_waitcnt vmcnt(11)
    v_permlane16_swap_b32 v8, v10
    v_permlane16_swap_b32_e64 v9, v11
    s_waitcnt lgkmcnt(3)
    s_nop 0
    v_mfma_f32_32x32x16_bf16 v[168:183], a[124:127], v[8:11], 0
    ds_read_b128 a[124:127], v4 offset:2048
    s_waitcnt vmcnt(10)
    v_permlane16_swap_b32 v12, v14
    v_permlane16_swap_b32_e64 v13, v15
    s_mov_b32 s24, 20971520
    v_mfma_f32_32x32x16_bf16 v[184:199], a[128:131], v[8:11], 0
    ds_read_b128 a[128:131], v5 offset:2048
    s_mov_b32 s25, 20975616
    s_mov_b32 s26, 20987904
    s_mov_b32 s27, 20992000
    s_mov_b32 s28, 21004288
    v_mfma_f32_32x32x16_bf16 v[200:215], a[132:135], v[8:11], 0
    ds_read_b128 a[132:135], v6 offset:2048
    s_add_u32 s61, s5, 131072
    buffer_load_dwordx4 v[56:59], v1, s[44:47], s61 offen sc1
    s_waitcnt lgkmcnt(3)
    v_mfma_f32_32x32x16_bf16 v[168:183], a[136:139], v[12:15], v[168:183]
    ds_read_b128 a[136:139], v4 offset:3072
    s_waitcnt vmcnt(10)
    v_permlane16_swap_b32 v16, v18
    v_permlane16_swap_b32 v17, v19
    s_mov_b32 s29, 21008384
    v_mfma_f32_32x32x16_bf16 v[184:199], a[140:143], v[12:15], v[184:199]
    ds_read_b128 a[140:143], v5 offset:3072
    v_mov_b32 v236, 0
    v_mov_b32 v237, 0
    v_mov_b32 v240, 0
    v_mov_b32 v241, 0
    v_mfma_f32_32x32x16_bf16 v[200:215], a[144:147], v[12:15], v[200:215]
    ds_read_b128 a[144:147], v6 offset:3072
    s_add_u32 s61, s5, 196608
    buffer_load_dwordx4 v[60:63], v1, s[44:47], s61 offen sc1
    s_waitcnt lgkmcnt(3)
    v_mfma_f32_32x32x16_bf16 v[168:183], a[124:127], v[16:19], v[168:183]
    ds_read_b128 a[124:127], v4 offset:4096
    s_waitcnt vmcnt(10)
    v_permlane16_swap_b32 v20, v22
    v_permlane16_swap_b32 v21, v23
    v_mov_b32_e64 v232, 0
    v_mfma_f32_32x32x16_bf16 v[184:199], a[128:131], v[16:19], v[184:199]
    ds_read_b128 a[128:131], v5 offset:4096
    v_mov_b32 v233, 0
    v_mov_b32 v234, 0
    v_mov_b32_e64 v235, 0
    v_mfma_f32_32x32x16_bf16 v[200:215], a[132:135], v[16:19], v[200:215]
    ds_read_b128 a[132:135], v6 offset:4096
    s_add_u32 s61, s5, 262144
    buffer_load_dwordx4 v[64:67], v1, s[44:47], s61 offen sc1
    s_waitcnt lgkmcnt(3)
    v_mfma_f32_32x32x16_bf16 v[168:183], a[136:139], v[20:23], v[168:183]
    ds_read_b128 a[136:139], v4 offset:5120
    s_waitcnt vmcnt(10)
    v_permlane16_swap_b32 v24, v26
    v_permlane16_swap_b32 v25, v27
    v_mfma_f32_32x32x16_bf16 v[184:199], a[140:143], v[20:23], v[184:199]
    ds_read_b128 a[140:143], v5 offset:5120
    v_mfma_f32_32x32x16_bf16 v[200:215], a[144:147], v[20:23], v[200:215]
    ds_read_b128 a[144:147], v6 offset:5120
    s_add_u32 s61, s5, 327680
    buffer_load_dwordx4 v[68:71], v1, s[44:47], s61 offen sc1
    s_waitcnt lgkmcnt(3)
    v_mfma_f32_32x32x16_bf16 v[168:183], a[124:127], v[24:27], v[168:183]
    ds_read_b128 a[124:127], v4 offset:6144
    s_waitcnt vmcnt(10)
    v_permlane16_swap_b32 v28, v30
    v_permlane16_swap_b32 v29, v31
    v_mfma_f32_32x32x16_bf16 v[184:199], a[128:131], v[24:27], v[184:199]
    ds_read_b128 a[128:131], v5 offset:6144
    v_mfma_f32_32x32x16_bf16 v[200:215], a[132:135], v[24:27], v[200:215]
    ds_read_b128 a[132:135], v6 offset:6144
    s_add_u32 s61, s5, 393216
    buffer_load_dwordx4 v[72:75], v1, s[44:47], s61 offen sc1
    s_waitcnt lgkmcnt(3)
    v_mfma_f32_32x32x16_bf16 v[168:183], a[136:139], v[28:31], v[168:183]
    ds_read_b128 a[136:139], v4 offset:7168
    s_waitcnt vmcnt(10)
    v_permlane16_swap_b32 v32, v34
    v_permlane16_swap_b32 v33, v35
    v_mfma_f32_32x32x16_bf16 v[184:199], a[140:143], v[28:31], v[184:199]
    ds_read_b128 a[140:143], v5 offset:7168
    v_mfma_f32_32x32x16_bf16 v[200:215], a[144:147], v[28:31], v[200:215]
    ds_read_b128 a[144:147], v6 offset:7168
    s_add_u32 s61, s5, 458752
    buffer_load_dwordx4 v[76:79], v1, s[44:47], s61 offen sc1
    s_waitcnt lgkmcnt(3)
    v_mfma_f32_32x32x16_bf16 v[168:183], a[124:127], v[32:35], v[168:183]
    ds_read_b128 a[124:127], v4 offset:8192
    s_waitcnt vmcnt(10)
    v_permlane16_swap_b32 v36, v38
    v_permlane16_swap_b32 v37, v39
    v_mfma_f32_32x32x16_bf16 v[184:199], a[128:131], v[32:35], v[184:199]
    ds_read_b128 a[128:131], v5 offset:8192
    v_mfma_f32_32x32x16_bf16 v[200:215], a[132:135], v[32:35], v[200:215]
    ds_read_b128 a[132:135], v6 offset:8192
    s_add_u32 s61, s5, 524288
    buffer_load_dwordx4 v[80:83], v1, s[44:47], s61 offen sc1
    s_waitcnt lgkmcnt(3)
    v_mfma_f32_32x32x16_bf16 v[168:183], a[136:139], v[36:39], v[168:183]
    ds_read_b128 a[136:139], v4 offset:9216
    s_waitcnt vmcnt(10)
    v_permlane16_swap_b32 v40, v42
    v_permlane16_swap_b32 v41, v43
    v_mfma_f32_32x32x16_bf16 v[184:199], a[140:143], v[36:39], v[184:199]
    ds_read_b128 a[140:143], v5 offset:9216
    v_mfma_f32_32x32x16_bf16 v[200:215], a[144:147], v[36:39], v[200:215]
    ds_read_b128 a[144:147], v6 offset:9216
    s_add_u32 s61, s5, 589824
    buffer_load_dwordx4 v[84:87], v1, s[44:47], s61 offen sc1
    s_waitcnt lgkmcnt(3)
    v_mfma_f32_32x32x16_bf16 v[168:183], a[124:127], v[40:43], v[168:183]
    ds_read_b128 a[124:127], v4 offset:10240
    s_waitcnt vmcnt(10)
    v_permlane16_swap_b32 v44, v46
    v_permlane16_swap_b32 v45, v47
    v_mfma_f32_32x32x16_bf16 v[184:199], a[128:131], v[40:43], v[184:199]
    ds_read_b128 a[128:131], v5 offset:10240
    v_mfma_f32_32x32x16_bf16 v[200:215], a[132:135], v[40:43], v[200:215]
    ds_read_b128 a[132:135], v6 offset:10240
    buffer_load_dwordx4 v[88:91], v1, s[44:47], s6 offen sc1
    s_set_gpr_idx_on s56, gpr_idx(SRC0,SRC1)
    s_nop 0
    v_dot2c_f32_bf16_e32 v232, s72, v8
    v_dot2c_f32_bf16_e32 v234, v8, v8
    v_dot2c_f32_bf16_e32 v233, s72, v9
    v_dot2c_f32_bf16_e32 v235, v9, v9
    v_dot2c_f32_bf16_e32 v232, s72, v10
    v_dot2c_f32_bf16_e32 v234, v10, v10
    v_dot2c_f32_bf16_e32 v233, s72, v11
    v_dot2c_f32_bf16_e32 v235, v11, v11
    v_dot2c_f32_bf16_e32 v232, s72, v12
    v_dot2c_f32_bf16_e32 v234, v12, v12
    v_dot2c_f32_bf16_e32 v233, s72, v13
    v_dot2c_f32_bf16_e32 v235, v13, v13
    v_dot2c_f32_bf16_e32 v232, s72, v14
    v_dot2c_f32_bf16_e32 v234, v14, v14
    v_dot2c_f32_bf16_e32 v233, s72, v15
    v_dot2c_f32_bf16_e32 v235, v15, v15
    v_dot2c_f32_bf16_e32 v232, s72, v16
    v_dot2c_f32_bf16_e32 v234, v16, v16
    v_dot2c_f32_bf16_e32 v233, s72, v17
    v_dot2c_f32_bf16_e32 v235, v17, v17
    s_set_gpr_idx_off
    s_waitcnt lgkmcnt(3)
    v_mfma_f32_32x32x16_bf16 v[168:183], a[136:139], v[44:47], v[168:183]
    ds_read_b128 a[136:139], v4 offset:11264
    s_waitcnt vmcnt(10)
    v_permlane16_swap_b32 v48, v50
    v_permlane16_swap_b32 v49, v51
    v_add_f32 v232, v232, v233
    v_mfma_f32_32x32x16_bf16 v[184:199], a[140:143], v[44:47], v[184:199]
    ds_read_b128 a[140:143], v5 offset:11264
    v_add_f32 v234, v234, v235
    v_mov_b32 v233, v232
    v_mov_b32 v235, v234
    v_cmp_gt_u32 vcc, 32, v0
    v_mfma_f32_32x32x16_bf16 v[200:215], a[144:147], v[44:47], v[200:215]
    ds_read_b128 a[144:147], v6 offset:11264
    s_add_u32 s61, s6, 65536
    buffer_load_dwordx4 v[92:95], v1, s[44:47], s61 offen sc1
    s_waitcnt lgkmcnt(3)
    v_mfma_f32_32x32x16_bf16 v[168:183], a[124:127], v[48:51], v[168:183]
    ds_read_b128 a[124:127], v4 offset:12288
    s_waitcnt vmcnt(10)
    v_permlane16_swap_b32 v52, v54
    v_permlane16_swap_b32 v53, v55
    v_permlane32_swap_b32_e64 v232, v233
    v_mfma_f32_32x32x16_bf16 v[184:199], a[128:131], v[48:51], v[184:199]
    ds_read_b128 a[128:131], v5 offset:12288
    v_permlane32_swap_b32 v234, v235
    v_add_f32 v216, v232, v233
    v_add_f32_e64 v217, v234, v235
    v_and_b32 v217, 0x7fffffff, v217
    v_mfma_f32_32x32x16_bf16 v[200:215], a[132:135], v[48:51], v[200:215]
    ds_read_b128 a[132:135], v6 offset:12288
    s_add_u32 s61, s6, 131072
    buffer_load_dwordx4 v[96:99], v1, s[44:47], s61 offen sc1
    s_waitcnt lgkmcnt(3)
    v_mfma_f32_32x32x16_bf16 v[168:183], a[136:139], v[52:55], v[168:183]
    ds_read_b128 a[136:139], v4 offset:13312
    s_waitcnt vmcnt(10)
    v_permlane16_swap_b32 v56, v58
    v_permlane16_swap_b32 v57, v59
    s_mov_b32 exec_hi, 0
    buffer_store_dwordx2 v[216:217], v251, s[44:47], s73 offen sc1
    s_mov_b32 exec_hi, -1
    v_mfma_f32_32x32x16_bf16 v[184:199], a[140:143], v[52:55], v[184:199]
    ds_read_b128 a[140:143], v5 offset:13312
    v_mfma_f32_32x32x16_bf16 v[200:215], a[144:147], v[52:55], v[200:215]
    ds_read_b128 a[144:147], v6 offset:13312
    s_add_u32 s61, s6, 196608
    buffer_load_dwordx4 v[100:103], v1, s[44:47], s61 offen sc1
    s_barrier
    s_waitcnt lgkmcnt(3)
    v_mfma_f32_32x32x16_bf16 v[168:183], a[124:127], v[56:59], v[168:183]
    ds_read_b128 a[124:127], v4 offset:14336
    s_waitcnt vmcnt(11)
    v_permlane16_swap_b32 v60, v62
    v_permlane16_swap_b32_e64 v61, v63
    v_mfma_f32_32x32x16_bf16 v[184:199], a[128:131], v[56:59], v[184:199]
    ds_read_b128 a[128:131], v5 offset:14336
    ds_write_b128 v252, a[160:163] offset:0
    v_mfma_f32_32x32x16_bf16 v[200:215], a[132:135], v[56:59], v[200:215]
    ds_read_b128 a[132:135], v6 offset:14336
    s_add_u32 s61, s6, 262144
    buffer_load_dwordx4 v[104:107], v1, s[44:47], s61 offen sc1
    s_waitcnt lgkmcnt(4)
    v_mfma_f32_32x32x16_bf16 v[168:183], a[136:139], v[60:63], v[168:183]
    ds_read_b128 a[136:139], v4 offset:15360
    s_waitcnt vmcnt(11)
    v_permlane16_swap_b32 v64, v66
    v_permlane16_swap_b32 v65, v67
    v_mfma_f32_32x32x16_bf16 v[184:199], a[140:143], v[60:63], v[184:199]
    ds_read_b128 a[140:143], v5 offset:15360
    ds_write_b128 v253, a[164:167] offset:0
    v_mfma_f32_32x32x16_bf16 v[200:215], a[144:147], v[60:63], v[200:215]
    ds_read_b128 a[144:147], v6 offset:15360
    s_add_u32 s61, s6, 327680
    buffer_load_dwordx4 v[108:111], v1, s[44:47], s61 offen sc1
    s_waitcnt lgkmcnt(4)
    v_mfma_f32_32x32x16_bf16 v[168:183], a[124:127], v[64:67], v[168:183]
    ds_read_b128 a[124:127], v4 offset:16384
    s_waitcnt vmcnt(11)
    v_permlane16_swap_b32 v68, v70
    v_permlane16_swap_b32 v69, v71
    v_mfma_f32_32x32x16_bf16 v[184:199], a[128:131], v[64:67], v[184:199]
    ds_read_b128 a[128:131], v5 offset:16384
    ds_write_b128 v252, a[168:171] offset:4096
    v_mfma_f32_32x32x16_bf16 v[200:215], a[132:135], v[64:67], v[200:215]
    ds_read_b128 a[132:135], v6 offset:16384
    s_add_u32 s61, s6, 393216
    buffer_load_dwordx4 v[112:115], v1, s[44:47], s61 offen sc1
    s_waitcnt lgkmcnt(4)
    v_mfma_f32_32x32x16_bf16 v[168:183], a[136:139], v[68:71], v[168:183]
    ds_read_b128 a[136:139], v4 offset:17408
    s_waitcnt vmcnt(11)
    v_permlane16_swap_b32 v72, v74
    v_permlane16_swap_b32 v73, v75
    v_mfma_f32_32x32x16_bf16 v[184:199], a[140:143], v[68:71], v[184:199]
    ds_read_b128 a[140:143], v5 offset:17408
    ds_write_b128 v253, a[172:175] offset:4096
    v_mfma_f32_32x32x16_bf16 v[200:215], a[144:147], v[68:71], v[200:215]
    ds_read_b128 a[144:147], v6 offset:17408
    s_add_u32 s61, s6, 458752
    buffer_load_dwordx4 v[116:119], v1, s[44:47], s61 offen sc1
    s_waitcnt lgkmcnt(4)
    v_mfma_f32_32x32x16_bf16 v[168:183], a[124:127], v[72:75], v[168:183]
    ds_read_b128 a[124:127], v4 offset:18432
    s_waitcnt vmcnt(11)
    v_permlane16_swap_b32 v76, v78
    v_permlane16_swap_b32 v77, v79
    v_mfma_f32_32x32x16_bf16 v[184:199], a[128:131], v[72:75], v[184:199]
    ds_read_b128 a[128:131], v5 offset:18432
    ds_write_b128 v252, a[176:179] offset:8192
    v_mfma_f32_32x32x16_bf16 v[200:215], a[132:135], v[72:75], v[200:215]
    ds_read_b128 a[132:135], v6 offset:18432
    s_add_u32 s61, s6, 524288
    buffer_load_dwordx4 v[120:123], v1, s[44:47], s61 offen sc1
    s_waitcnt lgkmcnt(4)
    v_mfma_f32_32x32x16_bf16 v[168:183], a[136:139], v[76:79], v[168:183]
    ds_read_b128 a[136:139], v4 offset:19456
    s_waitcnt vmcnt(11)
    v_permlane16_swap_b32 v80, v82
    v_permlane16_swap_b32 v81, v83
    v_mfma_f32_32x32x16_bf16 v[184:199], a[140:143], v[76:79], v[184:199]
    ds_read_b128 a[140:143], v5 offset:19456
    ds_write_b128 v253, a[180:183] offset:8192
    v_mfma_f32_32x32x16_bf16 v[200:215], a[144:147], v[76:79], v[200:215]
    ds_read_b128 a[144:147], v6 offset:19456
    s_add_u32 s61, s6, 589824
    buffer_load_dwordx4 v[124:127], v1, s[44:47], s61 offen sc1
    s_waitcnt lgkmcnt(4)
    v_mfma_f32_32x32x16_bf16 v[168:183], a[124:127], v[80:83], v[168:183]
    ds_read_b128 a[124:127], v4 offset:20480
    s_waitcnt vmcnt(11)
    v_permlane16_swap_b32 v84, v86
    v_permlane16_swap_b32 v85, v87
    v_mfma_f32_32x32x16_bf16 v[184:199], a[128:131], v[80:83], v[184:199]
    ds_read_b128 a[128:131], v5 offset:20480
    v_mfma_f32_32x32x16_bf16 v[200:215], a[132:135], v[80:83], v[200:215]
    ds_read_b128 a[132:135], v6 offset:20480
    buffer_load_dwordx4 v[128:131], v1, s[44:47], s7 offen sc1
    s_waitcnt lgkmcnt(3)
    v_mfma_f32_32x32x16_bf16 v[168:183], a[136:139], v[84:87], v[168:183]
    ds_read_b128 a[136:139], v4 offset:21504
    s_waitcnt vmcnt(11)
    v_permlane16_swap_b32 v88, v90
    v_permlane16_swap_b32 v89, v91
    v_mfma_f32_32x32x16_bf16 v[184:199], a[140:143], v[84:87], v[184:199]
    ds_read_b128 a[140:143], v5 offset:21504
    v_mfma_f32_32x32x16_bf16 v[200:215], a[144:147], v[84:87], v[200:215]
    ds_read_b128 a[144:147], v6 offset:21504
    s_add_u32 s61, s7, 65536
    buffer_load_dwordx4 v[132:135], v1, s[44:47], s61 offen sc1
    s_waitcnt lgkmcnt(3)
    v_mfma_f32_32x32x16_bf16 v[168:183], a[124:127], v[88:91], v[168:183]
    ds_read_b128 a[124:127], v4 offset:22528
    s_waitcnt vmcnt(11)
    v_permlane16_swap_b32 v92, v94
    v_permlane16_swap_b32 v93, v95
    v_mfma_f32_32x32x16_bf16 v[184:199], a[128:131], v[88:91], v[184:199]
    ds_read_b128 a[128:131], v5 offset:22528
    v_mfma_f32_32x32x16_bf16 v[200:215], a[132:135], v[88:91], v[200:215]
    ds_read_b128 a[132:135], v6 offset:22528
    s_add_u32 s61, s7, 131072
    buffer_load_dwordx4 v[136:139], v1, s[44:47], s61 offen sc1
    s_waitcnt lgkmcnt(3)
    v_mfma_f32_32x32x16_bf16 v[168:183], a[136:139], v[92:95], v[168:183]
    ds_read_b128 a[136:139], v4 offset:23552
    s_waitcnt vmcnt(11)
    v_permlane16_swap_b32 v96, v98
    v_permlane16_swap_b32 v97, v99
    v_mfma_f32_32x32x16_bf16 v[184:199], a[140:143], v[92:95], v[184:199]
    ds_read_b128 a[140:143], v5 offset:23552
    v_mfma_f32_32x32x16_bf16 v[200:215], a[144:147], v[92:95], v[200:215]
    ds_read_b128 a[144:147], v6 offset:23552
    s_add_u32 s61, s7, 196608
    buffer_load_dwordx4 v[140:143], v1, s[44:47], s61 offen sc1
    s_waitcnt lgkmcnt(3)
    v_mfma_f32_32x32x16_bf16 v[168:183], a[124:127], v[96:99], v[168:183]
    ds_read_b128 a[124:127], v4 offset:24576
    s_waitcnt vmcnt(10)
    v_permlane16_swap_b32 v100, v102
    v_permlane16_swap_b32 v101, v103
    v_mfma_f32_32x32x16_bf16 v[184:199], a[128:131], v[96:99], v[184:199]
    ds_read_b128 a[128:131], v5 offset:24576
    v_mfma_f32_32x32x16_bf16 v[200:215], a[132:135], v[96:99], v[200:215]
    ds_read_b128 a[132:135], v6 offset:24576
    s_add_u32 s61, s7, 262144
    buffer_load_dwordx4 v[144:147], v1, s[44:47], s61 offen sc1
    s_waitcnt lgkmcnt(3)
    v_mfma_f32_32x32x16_bf16 v[168:183], a[136:139], v[100:103], v[168:183]
    ds_read_b128 a[136:139], v4 offset:25600
    s_waitcnt vmcnt(10)
    v_permlane16_swap_b32 v104, v106
    v_permlane16_swap_b32 v105, v107
    buffer_load_dwordx2 v[216:217], v251, s[44:47], s74 offen offset:0 sc1
    v_mfma_f32_32x32x16_bf16 v[184:199], a[140:143], v[100:103], v[184:199]
    ds_read_b128 a[140:143], v5 offset:25600
    buffer_load_dwordx2 v[218:219], v251, s[44:47], s74 offen offset:256 sc1
    v_mfma_f32_32x32x16_bf16 v[200:215], a[144:147], v[100:103], v[200:215]
    ds_read_b128 a[144:147], v6 offset:25600
    s_add_u32 s61, s7, 327680
    buffer_load_dwordx4 v[148:151], v1, s[44:47], s61 offen sc1
    s_barrier
    s_waitcnt lgkmcnt(3)
    v_mfma_f32_32x32x16_bf16 v[168:183], a[124:127], v[104:107], v[168:183]
    ds_read_b128 a[124:127], v4 offset:26624
    s_waitcnt vmcnt(12)
    v_permlane16_swap_b32 v108, v110
    v_permlane16_swap_b32_e64 v109, v111
    buffer_load_dwordx2 v[220:221], v251, s[44:47], s74 offen offset:512 sc1
    v_mfma_f32_32x32x16_bf16 v[184:199], a[128:131], v[104:107], v[184:199]
    ds_read_b128 a[128:131], v5 offset:26624
    ds_write_b128 v252, a[184:187] offset:12288
    buffer_load_dwordx2 v[222:223], v251, s[44:47], s74 offen offset:768 sc1
    v_mfma_f32_32x32x16_bf16 v[200:215], a[132:135], v[104:107], v[200:215]
    ds_read_b128 a[132:135], v6 offset:26624
    s_add_u32 s61, s7, 393216
    buffer_load_dwordx4 v[152:155], v1, s[44:47], s61 offen sc1
    s_waitcnt lgkmcnt(4)
    v_mfma_f32_32x32x16_bf16 v[168:183], a[136:139], v[108:111], v[168:183]
    ds_read_b128 a[136:139], v4 offset:27648
    s_waitcnt vmcnt(14)
    v_permlane16_swap_b32 v112, v114
    v_permlane16_swap_b32 v113, v115
    buffer_load_dwordx2 v[224:225], v251, s[44:47], s74 offen offset:1024 sc1
    v_mfma_f32_32x32x16_bf16 v[184:199], a[140:143], v[108:111], v[184:199]
    ds_read_b128 a[140:143], v5 offset:27648
    ds_write_b128 v253, a[188:191] offset:12288
    buffer_load_dwordx2 v[226:227], v251, s[44:47], s74 offen offset:1280 sc1
    v_mfma_f32_32x32x16_bf16 v[200:215], a[144:147], v[108:111], v[200:215]
    ds_read_b128 a[144:147], v6 offset:27648
    s_add_u32 s61, s7, 458752
    buffer_load_dwordx4 v[156:159], v1, s[44:47], s61 offen sc1
    s_waitcnt lgkmcnt(4)
    v_mfma_f32_32x32x16_bf16 v[168:183], a[124:127], v[112:115], v[168:183]
    ds_read_b128 a[124:127], v4 offset:28672
    s_waitcnt vmcnt(16)
    v_permlane16_swap_b32 v116, v118
    v_permlane16_swap_b32 v117, v119
    buffer_load_dwordx2 v[228:229], v251, s[44:47], s74 offen offset:1536 sc1
    v_mfma_f32_32x32x16_bf16 v[184:199], a[128:131], v[112:115], v[184:199]
    ds_read_b128 a[128:131], v5 offset:28672
    ds_write_b128 v252, a[192:195] offset:16384
    buffer_load_dwordx2 v[230:231], v251, s[44:47], s74 offen offset:1792 sc1
    v_mfma_f32_32x32x16_bf16 v[200:215], a[132:135], v[112:115], v[200:215]
    ds_read_b128 a[132:135], v6 offset:28672
    s_add_u32 s61, s7, 524288
    buffer_load_dwordx4 v[160:163], v1, s[44:47], s61 offen sc1
    s_waitcnt lgkmcnt(4)
    v_mfma_f32_32x32x16_bf16 v[168:183], a[136:139], v[116:119], v[168:183]
    ds_read_b128 a[136:139], v4 offset:29696
    s_waitcnt vmcnt(18)
    v_permlane16_swap_b32 v120, v122
    v_permlane16_swap_b32 v121, v123
    v_mfma_f32_32x32x16_bf16 v[184:199], a[140:143], v[116:119], v[184:199]
    s_branch .Lover_3
.Lpad_3:
    s_setpc_b64 s[48:49]
.Lover_3:
    ds_read_b128 a[140:143], v5 offset:29696
    ds_write_b128 v253, a[196:199] offset:16384
    v_mfma_f32_32x32x16_bf16 v[200:215], a[144:147], v[116:119], v[200:215]
    ds_read_b128 a[144:147], v6 offset:29696
    s_add_u32 s61, s7, 589824
    buffer_load_dwordx4 v[164:167], v1, s[44:47], s61 offen sc1
    s_waitcnt lgkmcnt(4)
    v_mfma_f32_32x32x16_bf16 v[168:183], a[124:127], v[120:123], v[168:183]
    ds_read_b128 a[124:127], v4 offset:30720
    s_waitcnt vmcnt(18)
    v_permlane16_swap_b32 v124, v126
    v_permlane16_swap_b32 v125, v127
    v_mfma_f32_32x32x16_bf16 v[184:199], a[128:131], v[120:123], v[184:199]
    ds_read_b128 a[128:131], v5 offset:30720
    ds_write_b128 v252, a[200:203] offset:20480
    v_mfma_f32_32x32x16_bf16 v[200:215], a[132:135], v[120:123], v[200:215]
    ds_read_b128 a[132:135], v6 offset:30720
    buffer_load_dwordx4 a[148:151], v246, s[44:47], s62 offen sc1
    s_waitcnt lgkmcnt(4)
    v_mfma_f32_32x32x16_bf16 v[168:183], a[136:139], v[124:127], v[168:183]
    ds_read_b128 a[136:139], v4 offset:31744
    s_waitcnt vmcnt(18)
    v_permlane16_swap_b32 v128, v130
    v_permlane16_swap_b32 v129, v131
    v_mfma_f32_32x32x16_bf16 v[184:199], a[140:143], v[124:127], v[184:199]
    ds_read_b128 a[140:143], v5 offset:31744
    ds_write_b128 v253, a[204:207] offset:20480
    v_mfma_f32_32x32x16_bf16 v[200:215], a[144:147], v[124:127], v[200:215]
    ds_read_b128 a[144:147], v6 offset:31744
    buffer_load_dwordx4 a[152:155], v246, s[44:47], s62 offen offset:256 sc1
    s_waitcnt lgkmcnt(4)
    v_mfma_f32_32x32x16_bf16 v[168:183], a[124:127], v[128:131], v[168:183]
    ds_read_b128 a[124:127], v4 offset:32768
    s_waitcnt vmcnt(18)
    v_permlane16_swap_b32 v132, v134
    v_permlane16_swap_b32 v133, v135
    v_mfma_f32_32x32x16_bf16 v[184:199], a[128:131], v[128:131], v[184:199]
    ds_read_b128 a[128:131], v5 offset:32768
    v_mfma_f32_32x32x16_bf16 v[200:215], a[132:135], v[128:131], v[200:215]
    ds_read_b128 a[132:135], v6 offset:32768
    buffer_load_dwordx4 a[156:159], v246, s[44:47], s63 offen sc1
    s_waitcnt lgkmcnt(3)
    v_mfma_f32_32x32x16_bf16 v[168:183], a[136:139], v[132:135], v[168:183]
    ds_read_b128 a[136:139], v4 offset:33792
    s_waitcnt vmcnt(18)
    v_permlane16_swap_b32 v136, v138
    v_permlane16_swap_b32 v137, v139
    v_mfma_f32_32x32x16_bf16 v[184:199], a[140:143], v[132:135], v[184:199]
    ds_read_b128 a[140:143], v5 offset:33792
    v_mfma_f32_32x32x16_bf16 v[200:215], a[144:147], v[132:135], v[200:215]
    ds_read_b128 a[144:147], v6 offset:33792
    s_mov_b32 s68, 2102272
    buffer_load_dwordx4 a[80:83], v247, s[44:47], s68 offen offset:0 sc1
    s_barrier
    s_waitcnt lgkmcnt(3)
    v_mfma_f32_32x32x16_bf16 v[168:183], a[124:127], v[136:139], v[168:183]
    ds_read_b128 a[124:127], v4 offset:34816
    s_waitcnt vmcnt(18)
    v_permlane16_swap_b32 v140, v142
    v_permlane16_swap_b32_e64 v141, v143
    v_mfma_f32_32x32x16_bf16 v[184:199], a[128:131], v[136:139], v[184:199]
    ds_read_b128 a[128:131], v5 offset:34816
    ds_write_b128 v252, a[208:211] offset:24576
    v_mfma_f32_32x32x16_bf16 v[200:215], a[132:135], v[136:139], v[200:215]
    ds_read_b128 a[132:135], v6 offset:34816
    buffer_load_dwordx4 a[84:87], v247, s[44:47], s68 offen offset:1024 sc1
    s_waitcnt lgkmcnt(4)
    v_mfma_f32_32x32x16_bf16 v[168:183], a[136:139], v[140:143], v[168:183]
    ds_read_b128 a[136:139], v4 offset:35840
    s_waitcnt vmcnt(18)
    v_permlane16_swap_b32_e64 v144, v146
    v_permlane16_swap_b32 v145, v147
    s_waitcnt vmcnt(14)
    v_or3_b32 v250, v217, v219, v221
    s_waitcnt vmcnt(10)
    v_or3_b32 v249, v223, v225, v227
    s_waitcnt vmcnt(7)
    v_or3_b32 v250, v250, v229, v231
    v_mfma_f32_32x32x16_bf16 v[184:199], a[140:143], v[140:143], v[184:199]
    ds_read_b128 a[140:143], v5 offset:35840
    ds_write_b128 v253, a[212:215] offset:24576
    v_or_b32_e64 v250, v250, v249
    v_mfma_f32_32x32x16_bf16 v[200:215], a[144:147], v[140:143], v[200:215]
    ds_read_b128 a[144:147], v6 offset:35840
    buffer_load_dwordx4 a[88:91], v247, s[44:47], s68 offen offset:2048 sc1
    v_cmp_gt_i32 vcc, 0, v250
    s_nop 1
    s_cbranch_vccnz .Lslow_23
.Lback_24:
    s_waitcnt lgkmcnt(4)
    v_mfma_f32_32x32x16_bf16 v[168:183], a[124:127], v[144:147], v[168:183]
    ds_read_b128 a[124:127], v4 offset:36864
    v_permlane16_swap_b32 v148, v150
    v_permlane16_swap_b32 v149, v151
    v_add_f32 v216, v216, v218
    v_add_f32 v220, v220, v222
    v_add_f32_e64 v224, v224, v226
    v_mfma_f32_32x32x16_bf16 v[184:199], a[128:131], v[144:147], v[184:199]
    ds_read_b128 a[128:131], v5 offset:36864
    ds_write_b128 v252, a[216:219] offset:28672
    v_add_f32_e64 v228, v228, v230
    v_mfma_f32_32x32x16_bf16 v[200:215], a[132:135], v[144:147], v[200:215]
    ds_read_b128 a[132:135], v6 offset:36864
    buffer_load_dwordx4 a[92:95], v247, s[44:47], s68 offen offset:3072 sc1
    v_add_f32_e64 v232, v216, v220
    v_add_f32 v233, v224, v228
    s_waitcnt lgkmcnt(4)
    v_mfma_f32_32x32x16_bf16 v[168:183], a[136:139], v[148:151], v[168:183]
    ds_read_b128 a[136:139], v4 offset:37888
    v_permlane16_swap_b32 v152, v154
    v_permlane16_swap_b32 v153, v155
    v_add_f32 v217, v217, v219
    v_add_f32 v221, v221, v223
    v_add_f32_e64 v225, v225, v227
    v_mfma_f32_32x32x16_bf16 v[184:199], a[140:143], v[148:151], v[184:199]
    ds_read_b128 a[140:143], v5 offset:37888
    ds_write_b128 v253, a[220:223] offset:28672
    v_add_f32_e64 v229, v229, v231
    v_mfma_f32_32x32x16_bf16 v[200:215], a[144:147], v[148:151], v[200:215]
    ds_read_b128 a[144:147], v6 offset:37888
    buffer_load_dwordx4 a[96:99], v255, s[44:47], s68 offen offset:0 sc1
    v_add_f32_e64 v234, v217, v221
    v_add_f32 v235, v225, v229
    s_waitcnt lgkmcnt(4)
    v_mfma_f32_32x32x16_bf16 v[168:183], a[124:127], v[152:155], v[168:183]
    ds_read_b128 a[124:127], v4 offset:38912
    v_permlane16_swap_b32 v156, v158
    v_permlane16_swap_b32 v157, v159
    v_add_f32 v232, v232, v233
    v_add_f32 v234, v234, v235
    v_mov_b32_e64 v233, v232
    v_mfma_f32_32x32x16_bf16 v[184:199], a[128:131], v[152:155], v[184:199]
    ds_read_b128 a[128:131], v5 offset:38912
    v_mov_b32 v235, v234
    v_cmp_gt_u32 vcc, 32, v0
    v_permlane32_swap_b32 v232, v233
    v_permlane32_swap_b32 v234, v235
    v_add_f32_e64 v232, v232, v233
    v_mfma_f32_32x32x16_bf16 v[200:215], a[132:135], v[152:155], v[200:215]
    ds_read_b128 a[132:135], v6 offset:38912
    s_mov_b32 s68, 2122752
    buffer_load_dwordx4 a[100:103], v247, s[44:47], s68 offen offset:0 sc1
    v_add_f32 v234, v234, v235
    v_mul_f32 v232, 0xbacccccd, v232
    s_waitcnt lgkmcnt(3)
    v_mfma_f32_32x32x16_bf16 v[168:183], a[136:139], v[156:159], v[168:183]
    ds_read_b128 a[136:139], v4 offset:39936
    s_waitcnt vmcnt(10)
    v_permlane16_swap_b32 v160, v162
    v_permlane16_swap_b32_e64 v161, v163
    v_mul_f32 v234, 0x3acccccd, v234
    v_cvt_pk_bf16_f32 v250, v232, 0
    v_fma_f32 v234, -v232, v232, v234
    v_mfma_f32_32x32x16_bf16 v[184:199], a[140:143], v[156:159], v[184:199]
    ds_read_b128 a[140:143], v5 offset:39936
    v_cndmask_b32 v238, 0, v250, vcc
    v_max_f32 v234, 0, v234
    v_cndmask_b32_e64 v239, 0, v250, vcc
    v_cvt_pk_bf16_f32 v234, 0, v234
    v_add_f32 v234, 0x3727c5ac, v234
    v_mfma_f32_32x32x16_bf16 v[200:215], a[144:147], v[156:159], v[200:215]
    ds_read_b128 a[144:147], v6 offset:39936
    buffer_load_dwordx4 a[104:107], v247, s[44:47], s68 offen offset:1024 sc1
    v_cvt_pk_bf16_f32 v234, 0, v234
    v_sqrt_f32 v234, v234
    s_waitcnt lgkmcnt(3)
    v_mfma_f32_32x32x16_bf16 v[168:183], a[124:127], v[160:163], v[168:183]
    ds_read_b128 a[240:243], v7 offset:0
    s_waitcnt vmcnt(10)
    v_permlane16_swap_b32 v164, v166
    v_permlane16_swap_b32_e64 v165, v167
    v_cvt_pk_bf16_f32 v234, 0, v234
    v_rcp_f32 v235, v234
    v_mul_f32 v234, v234, v234
    v_mfma_f32_32x32x16_bf16 v[184:199], a[128:131], v[160:163], v[184:199]
    ds_read_b128 a[244:247], v7 offset:1024
    v_mul_f32 v232, 0xc0135761, v235
    v_mul_f32_e64 v250, v235, v235
    v_mul_f32 v250, 0x3d372713, v250
    v_mul_f32_e64 v233, v250, v232
    v_mfma_f32_32x32x16_bf16 v[200:215], a[132:135], v[160:163], v[200:215]
    ds_read_b128 a[248:251], v7 offset:2048
    buffer_load_dwordx4 a[108:111], v247, s[44:47], s68 offen offset:2048 sc1
    s_waitcnt lgkmcnt(3)
    v_mfma_f32_32x32x16_bf16 v[168:183], a[136:139], v[164:167], v[168:183]
    ds_read_b128 a[252:255], v7 offset:3072
    s_barrier
    v_mfma_f32_32x32x16_bf16 v[184:199], a[140:143], v[164:167], v[184:199]
    ds_write_b128 v252, a[224:227] offset:32768
    v_mfma_f32_32x32x16_bf16 v[200:215], a[144:147], v[164:167], v[200:215]
    ds_write_b128 v253, a[228:231] offset:32768
    s_nop 0
    s_waitcnt vmcnt(10)
    v_mfma_f32_32x32x16_bf16 v[168:183], a[148:151], v[238:241], v[168:183]
    ds_write_b128 v252, a[232:235] offset:36864
    v_mfma_f32_32x32x16_bf16 v[184:199], a[148:151], v[236:239], v[184:199]
    ds_write_b128 v253, a[236:239] offset:36864
    s_waitcnt vmcnt(9)
    v_mfma_f32_32x32x16_bf16 v[200:215], a[152:155], v[238:241], v[200:215]
    v_mfma_f32_32x32x16_bf16 v[216:231], a[152:155], v[236:239], 0
    s_waitcnt lgkmcnt(6)
    v_mfma_f32_32x32x16_bf16 v[216:231], a[240:243], v[8:11], v[216:231]
    ds_read_b128 a[224:227], v7 offset:4096
    ds_read_b128 a[228:231], v7 offset:5120
    v_mfma_f32_32x32x16_bf16 v[216:231], a[244:247], v[12:15], v[216:231]
    ds_read_b128 a[232:235], v7 offset:6144
    ds_read_b128 a[236:239], v7 offset:7168
    v_mul_f32 v242, v168, v168
    v_mul_f32 v243, v169, v169
    v_mul_f32 v244, v170, v170
    s_waitcnt lgkmcnt(8)
    v_mfma_f32_32x32x16_bf16 v[216:231], a[248:251], v[16:19], v[216:231]
    ds_read_b128 a[240:243], v7 offset:8192
    ds_read_b128 a[244:247], v7 offset:9216
    v_mul_f32_e64 v245, v171, v171
    v_fma_f32 v242, v242, v233, v232
    v_fma_f32 v243, v243, v233, v232
    v_fma_f32 v244, v244, v233, v232
    v_fma_f32 v245, v245, v233, v232
    v_mfma_f32_32x32x16_bf16 v[216:231], a[252:255], v[20:23], v[216:231]
    ds_read_b128 a[248:251], v7 offset:10240
    ds_read_b128 a[252:255], v7 offset:11264
    v_mul_f32 v242, v242, v168
    v_mul_f32 v243, v243, v169
    v_mul_f32 v244, v244, v170
    s_waitcnt lgkmcnt(6)
    v_mfma_f32_32x32x16_bf16 v[216:231], a[224:227], v[24:27], v[216:231]
    ds_read_b128 a[224:227], v7 offset:12288
    buffer_load_dwordx4 a[112:115], v247, s[44:47], s68 offen offset:3072 sc1
    v_mul_f32 v245, v245, v171
    v_exp_f32 v242, v242
    v_mul_f32_e64 v172, v172, v168
    v_mfma_f32_32x32x16_bf16 v[216:231], a[228:231], v[28:31], v[216:231]
    ds_read_b128 a[228:231], v7 offset:13312
    v_exp_f32_e64 v243, v243
    v_mul_f32 v173, v173, v169
    s_waitcnt lgkmcnt(6)
    v_mfma_f32_32x32x16_bf16 v[216:231], a[232:235], v[32:35], v[216:231]
    ds_read_b128 a[232:235], v7 offset:14336
    buffer_load_dwordx4 a[116:119], v255, s[44:47], s68 offen offset:0 sc1
    v_exp_f32 v244, v244
    v_mul_f32 v174, v174, v170
    v_mfma_f32_32x32x16_bf16 v[216:231], a[236:239], v[36:39], v[216:231]
    ds_read_b128 a[236:239], v7 offset:15360
    v_exp_f32_e64 v245, v245
    v_mul_f32 v175, v175, v171
    v_fma_f32 v242, v242, v234, v234
    v_fma_f32 v243, v243, v234, v234
    s_waitcnt lgkmcnt(6)
    v_mfma_f32_32x32x16_bf16 v[216:231], a[240:243], v[40:43], v[216:231]
    ds_read_b128 a[240:243], v7 offset:16384
    v_fma_f32 v244, v244, v234, v234
    v_fma_f32 v245, v245, v234, v234
    v_rcp_f32 v242, v242
    v_rcp_f32 v243, v243
    v_mfma_f32_32x32x16_bf16 v[216:231], a[244:247], v[44:47], v[216:231]
    ds_read_b128 a[244:247], v7 offset:17408
    s_mov_b32 s68, 2132992
    buffer_load_dwordx4 a[120:123], v247, s[44:47], s68 offen offset:0 sc1
    s_waitcnt lgkmcnt(6)
    v_mfma_f32_32x32x16_bf16 v[216:231], a[248:251], v[48:51], v[216:231]
    ds_read_b128 a[248:251], v7 offset:18432
    v_rcp_f32 v244, v244
    v_rcp_f32 v245, v245
    v_mul_f32 v172, v172, v242
    v_mul_f32_e64 v173, v173, v243
    v_mfma_f32_32x32x16_bf16 v[216:231], a[252:255], v[52:55], v[216:231]
    ds_read_b128 a[252:255], v7 offset:19456
    buffer_load_dwordx4 a[124:127], v247, s[44:47], s68 offen offset:1024 sc1
    v_mul_f32_e64 v174, v174, v244
    v_mul_f32 v175, v175, v245
    v_cvt_pk_bf16_f32 v168, v172, v173
    s_waitcnt lgkmcnt(4)
    v_mfma_f32_32x32x16_bf16 v[216:231], a[224:227], v[56:59], v[216:231]
    ds_read_b128 a[224:227], v7 offset:20480
    v_cvt_pk_bf16_f32 v169, v174, v175
    v_mul_f32 v242, v176, v176
    v_mul_f32 v243, v177, v177
    v_mul_f32 v244, v178, v178
    v_mul_f32 v245, v179, v179
    v_mfma_f32_32x32x16_bf16 v[216:231], a[228:231], v[60:63], v[216:231]
    ds_read_b128 a[228:231], v7 offset:21504
    v_fma_f32 v242, v242, v233, v232
    v_fma_f32 v243, v243, v233, v232
    v_fma_f32 v244, v244, v233, v232
    v_fma_f32 v245, v245, v233, v232
    v_mul_f32 v242, v242, v176
    v_mul_f32 v243, v243, v177
    v_mfma_f32_32x32x16_bf16 v[216:231], a[232:235], v[64:67], v[216:231]
    ds_read_b128 a[232:235], v7 offset:22528
    buffer_load_dwordx4 a[128:131], v247, s[44:47], s68 offen offset:2048 sc1
    v_mul_f32 v244, v244, v178
    v_mul_f32 v245, v245, v179
    v_mfma_f32_32x32x16_bf16 v[216:231], a[236:239], v[68:71], v[216:231]
    ds_read_b128 a[236:239], v7 offset:23552
    v_exp_f32 v242, v242
    v_mul_f32 v180, v180, v176
    v_exp_f32 v243, v243
    s_waitcnt lgkmcnt(4)
    v_mfma_f32_32x32x16_bf16 v[216:231], a[240:243], v[72:75], v[216:231]
    ds_read_b128 a[240:243], v7 offset:24576
    v_mul_f32 v181, v181, v177
    v_exp_f32 v244, v244
    v_mul_f32 v182, v182, v178
    v_exp_f32 v245, v245
    v_mfma_f32_32x32x16_bf16 v[216:231], a[244:247], v[76:79], v[216:231]
    ds_read_b128 a[244:247], v7 offset:25600
    buffer_load_dwordx4 a[132:135], v247, s[44:47], s68 offen offset:3072 sc1
    v_mul_f32_e64 v183, v183, v179
    v_fma_f32 v242, v242, v234, v234
    v_fma_f32 v243, v243, v234, v234
    v_mfma_f32_32x32x16_bf16 v[216:231], a[248:251], v[80:83], v[216:231]
    ds_read_b128 a[248:251], v7 offset:26624
    v_fma_f32 v244, v244, v234, v234
    v_fma_f32 v245, v245, v234, v234
    v_rcp_f32 v242, v242
    v_rcp_f32 v243, v243
    v_mfma_f32_32x32x16_bf16 v[216:231], a[252:255], v[84:87], v[216:231]
    ds_read_b128 a[252:255], v7 offset:27648
    buffer_load_dwordx4 a[136:139], v255, s[44:47], s68 offen offset:0 sc1
    v_rcp_f32 v244, v244
    s_waitcnt lgkmcnt(4)
    v_mfma_f32_32x32x16_bf16 v[216:231], a[224:227], v[88:91], v[216:231]
    ds_read_b128 a[224:227], v7 offset:28672
    v_rcp_f32 v245, v245
    v_mul_f32 v180, v180, v242
    v_mul_f32 v181, v181, v243
    v_mul_f32 v182, v182, v244
    v_mul_f32_e64 v183, v183, v245
    v_mfma_f32_32x32x16_bf16 v[216:231], a[228:231], v[92:95], v[216:231]
    ds_read_b128 a[228:231], v7 offset:29696
    v_cvt_pk_bf16_f32 v170, v180, v181
    v_cvt_pk_bf16_f32 v171, v182, v183
    buffer_store_dwordx4 v[168:171], v2, s[44:47], s57 offen offset:0 sc1
    v_mfma_f32_32x32x16_bf16 v[216:231], a[232:235], v[96:99], v[216:231]
    ds_read_b128 a[232:235], v7 offset:30720
    s_mov_b32 s68, 2153472
    buffer_load_dwordx4 a[140:143], v247, s[44:47], s68 offen offset:0 sc1
    v_mul_f32_e64 v242, v184, v184
    v_mfma_f32_32x32x16_bf16 v[216:231], a[236:239], v[100:103], v[216:231]
    ds_read_b128 a[236:239], v7 offset:31744
    v_mul_f32 v243, v185, v185
    v_mul_f32 v244, v186, v186
    v_mul_f32 v245, v187, v187
    v_fma_f32 v242, v242, v233, v232
    v_fma_f32 v243, v243, v233, v232
    s_waitcnt lgkmcnt(4)
    v_mfma_f32_32x32x16_bf16 v[216:231], a[240:243], v[104:107], v[216:231]
    ds_read_b128 a[240:243], v7 offset:32768
    v_fma_f32 v244, v244, v233, v232
    v_fma_f32 v245, v245, v233, v232
    v_mul_f32 v242, v242, v184
    v_mul_f32 v243, v243, v185
    v_mul_f32_e64 v244, v244, v186
    v_mfma_f32_32x32x16_bf16 v[216:231], a[244:247], v[108:111], v[216:231]
    ds_read_b128 a[244:247], v7 offset:33792
    buffer_load_dwordx4 a[144:147], v247, s[44:47], s68 offen offset:1024 sc1
    v_mul_f32 v245, v245, v187
    v_exp_f32 v242, v242
    v_mul_f32_e64 v188, v188, v184
    v_mfma_f32_32x32x16_bf16 v[216:231], a[248:251], v[112:115], v[216:231]
    ds_read_b128 a[248:251], v7 offset:34816
    s_barrier
    v_exp_f32 v243, v243
    v_mul_f32_e64 v189, v189, v185
    v_mfma_f32_32x32x16_bf16 v[216:231], a[252:255], v[116:119], v[216:231]
    ds_read_b128 a[252:255], v7 offset:35840
    buffer_load_dwordx4 a[148:151], v247, s[44:47], s68 offen offset:2048 sc1
    v_exp_f32_e64 v244, v244
    v_mul_f32 v190, v190, v186
    s_waitcnt lgkmcnt(4)
    v_mfma_f32_32x32x16_bf16 v[216:231], a[224:227], v[120:123], v[216:231]
    ds_read_b128 a[224:227], v7 offset:36864
    v_exp_f32 v245, v245
    v_mul_f32 v191, v191, v187
    v_fma_f32 v242, v242, v234, v234
    v_fma_f32 v243, v243, v234, v234
    v_fma_f32 v244, v244, v234, v234
    v_mfma_f32_32x32x16_bf16 v[216:231], a[228:231], v[124:127], v[216:231]
    ds_read_b128 a[228:231], v7 offset:37888
    v_fma_f32 v245, v245, v234, v234
    v_rcp_f32 v242, v242
    v_rcp_f32 v243, v243
    v_mfma_f32_32x32x16_bf16 v[216:231], a[232:235], v[128:131], v[216:231]
    ds_read_b128 a[232:235], v7 offset:38912
    buffer_load_dwordx4 a[152:155], v247, s[44:47], s68 offen offset:3072 sc1
    v_rcp_f32 v244, v244
    v_rcp_f32 v245, v245
    v_mfma_f32_32x32x16_bf16 v[216:231], a[236:239], v[132:135], v[216:231]
    ds_read_b128 a[236:239], v7 offset:39936
    v_mul_f32 v188, v188, v242
    v_mul_f32 v189, v189, v243
    v_mul_f32_e64 v190, v190, v244
    v_mul_f32 v191, v191, v245
    s_waitcnt lgkmcnt(4)
    v_mfma_f32_32x32x16_bf16 v[216:231], a[240:243], v[136:139], v[216:231]
    ds_read_b128 a[240:243], v4 offset:0
    v_cvt_pk_bf16_f32 v184, v188, v189
    v_cvt_pk_bf16_f32 v185, v190, v191
    v_mul_f32 v242, v192, v192
    v_mul_f32 v243, v193, v193
    v_mul_f32 v244, v194, v194
    v_mul_f32 v245, v195, v195
    v_mfma_f32_32x32x16_bf16 v[216:231], a[244:247], v[140:143], v[216:231]
    ds_read_b128 a[244:247], v4 offset:1024
    v_fma_f32 v242, v242, v233, v232
    v_fma_f32 v243, v243, v233, v232
    v_fma_f32 v244, v244, v233, v232
    v_fma_f32 v245, v245, v233, v232
    v_mul_f32 v242, v242, v192
    v_mul_f32 v243, v243, v193
    v_mfma_f32_32x32x16_bf16 v[216:231], a[248:251], v[144:147], v[216:231]
    ds_read_b128 a[248:251], v4 offset:2048
    v_mul_f32 v244, v244, v194
    v_mul_f32 v245, v245, v195
    v_exp_f32 v242, v242
    v_mul_f32 v196, v196, v192
    v_mfma_f32_32x32x16_bf16 v[216:231], a[252:255], v[148:151], v[216:231]
    ds_read_b128 a[252:255], v4 offset:3072
    s_mov_b32 s68, 2107392
    buffer_load_dwordx4 a[160:163], v247, s[44:47], s68 offen offset:0 sc1
    v_exp_f32 v243, v243
    s_waitcnt lgkmcnt(4)
    v_mfma_f32_32x32x16_bf16 v[216:231], a[224:227], v[152:155], v[216:231]
    ds_read_b128 a[224:227], v4 offset:4096
    v_mul_f32 v197, v197, v193
    v_exp_f32 v244, v244
    v_mul_f32_e64 v198, v198, v194
    v_mfma_f32_32x32x16_bf16 v[216:231], a[228:231], v[156:159], v[216:231]
    ds_read_b128 a[228:231], v4 offset:5120
    v_exp_f32 v245, v245
    v_mul_f32 v199, v199, v195
    v_fma_f32 v242, v242, v234, v234
    v_fma_f32 v243, v243, v234, v234
    v_fma_f32 v244, v244, v234, v234
    v_mfma_f32_32x32x16_bf16 v[216:231], a[232:235], v[160:163], v[216:231]
    ds_read_b128 a[232:235], v4 offset:6144
    buffer_load_dwordx4 a[164:167], v247, s[44:47], s68 offen offset:1024 sc1
    v_fma_f32 v245, v245, v234, v234
    v_rcp_f32_e64 v242, v242
    v_mfma_f32_32x32x16_bf16 v[216:231], a[236:239], v[164:167], v[216:231]
    ds_read_b128 a[236:239], v4 offset:7168
    v_rcp_f32_e64 v243, v243
    v_rcp_f32 v244, v244
    s_waitcnt vmcnt(22)
    v_mfma_f32_32x32x16_bf16 v[168:183], a[156:159], v[238:241], 0
    v_rcp_f32 v245, v245
    v_mul_f32 v196, v196, v242
    v_mul_f32 v197, v197, v243
    v_mul_f32 v198, v198, v244
    v_mul_f32 v199, v199, v245
    s_waitcnt lgkmcnt(4)
    v_mfma_f32_32x32x16_bf16 v[168:183], a[240:243], v[8:11], v[168:183]
    ds_read_b128 a[240:243], v4 offset:8192
    v_cvt_pk_bf16_f32 v186, v196, v197
    v_cvt_pk_bf16_f32 v187, v198, v199
    buffer_store_dwordx4 v[184:187], v2, s[44:47], s57 offen offset:1024 sc1
    v_mfma_f32_32x32x16_bf16 v[168:183], a[244:247], v[12:15], v[168:183]
    ds_read_b128 a[244:247], v4 offset:9216
    buffer_load_dwordx4 a[168:171], v247, s[44:47], s68 offen offset:2048 sc1
    v_mul_f32 v242, v200, v200
    v_mul_f32 v243, v201, v201
    v_mfma_f32_32x32x16_bf16 v[168:183], a[248:251], v[16:19], v[168:183]
    ds_read_b128 a[248:251], v4 offset:10240
    v_mul_f32 v244, v202, v202
    v_mul_f32 v245, v203, v203
    v_fma_f32 v242, v242, v233, v232
    v_fma_f32 v243, v243, v233, v232
    v_fma_f32 v244, v244, v233, v232
    v_mfma_f32_32x32x16_bf16 v[168:183], a[252:255], v[20:23], v[168:183]
    ds_read_b128 a[252:255], v4 offset:11264
    buffer_load_dwordx4 a[172:175], v247, s[44:47], s68 offen offset:3072 sc1
    v_fma_f32 v245, v245, v233, v232
    v_mul_f32_e64 v242, v242, v200
    v_mul_f32 v243, v243, v201
    s_waitcnt lgkmcnt(4)
    v_mfma_f32_32x32x16_bf16 v[168:183], a[224:227], v[24:27], v[168:183]
    ds_read_b128 a[224:227], v4 offset:12288
    v_mul_f32 v244, v244, v202
    v_mul_f32 v245, v245, v203
    v_exp_f32 v242, v242
    v_mul_f32 v204, v204, v200
    v_mfma_f32_32x32x16_bf16 v[168:183], a[228:231], v[28:31], v[168:183]
    ds_read_b128 a[228:231], v4 offset:13312
    v_exp_f32 v243, v243
    v_mul_f32 v205, v205, v201
    v_exp_f32 v244, v244
    v_mul_f32 v206, v206, v202
    v_mfma_f32_32x32x16_bf16 v[168:183], a[232:235], v[32:35], v[168:183]
    ds_read_b128 a[232:235], v4 offset:14336
    buffer_load_dwordx4 a[176:179], v255, s[44:47], s68 offen offset:0 sc1
    v_exp_f32 v245, v245
    v_mul_f32 v207, v207, v203
    v_fma_f32 v242, v242, v234, v234
    v_mfma_f32_32x32x16_bf16 v[168:183], a[236:239], v[36:39], v[168:183]
    ds_read_b128 a[236:239], v4 offset:15360
    v_fma_f32 v243, v243, v234, v234
    v_fma_f32 v244, v244, v234, v234
    v_fma_f32 v245, v245, v234, v234
    s_nop 0
    s_waitcnt lgkmcnt(4)
    v_mfma_f32_32x32x16_bf16 v[168:183], a[240:243], v[40:43], v[168:183]
    ds_read_b128 a[240:243], v4 offset:16384
    s_mov_b32 s68, 2112512
    buffer_load_dwordx4 a[180:183], v247, s[44:47], s68 offen offset:0 sc1
    v_rcp_f32_e64 v242, v242
    v_mfma_f32_32x32x16_bf16 v[168:183], a[244:247], v[44:47], v[168:183]
    ds_read_b128 a[244:247], v4 offset:17408
    v_rcp_f32 v243, v243
    v_rcp_f32 v244, v244
    v_rcp_f32_e64 v245, v245
    v_mfma_f32_32x32x16_bf16 v[168:183], a[248:251], v[48:51], v[168:183]
    ds_read_b128 a[248:251], v4 offset:18432
    s_barrier
    v_mul_f32 v204, v204, v242
    v_mul_f32 v205, v205, v243
    v_mul_f32 v206, v206, v244
    v_mul_f32_e64 v207, v207, v245
    v_mfma_f32_32x32x16_bf16 v[168:183], a[252:255], v[52:55], v[168:183]
    ds_read_b128 a[252:255], v4 offset:19456
    buffer_load_dwordx4 a[184:187], v247, s[44:47], s68 offen offset:1024 sc1
    v_cvt_pk_bf16_f32 v200, v204, v205
    v_cvt_pk_bf16_f32 v201, v206, v207
    s_waitcnt lgkmcnt(4)
    v_mfma_f32_32x32x16_bf16 v[168:183], a[224:227], v[56:59], v[168:183]
    ds_read_b128 a[224:227], v4 offset:20480
    v_mul_f32 v242, v208, v208
    v_mul_f32 v243, v209, v209
    v_mul_f32 v244, v210, v210
    v_mul_f32_e64 v245, v211, v211
    v_fma_f32 v242, v242, v233, v232
    v_fma_f32 v243, v243, v233, v232
    v_mfma_f32_32x32x16_bf16 v[168:183], a[228:231], v[60:63], v[168:183]
    ds_read_b128 a[228:231], v4 offset:21504
    v_fma_f32 v244, v244, v233, v232
    v_fma_f32 v245, v245, v233, v232
    v_mul_f32 v242, v242, v208
    v_mul_f32 v243, v243, v209
    v_mul_f32_e64 v244, v244, v210
    v_mfma_f32_32x32x16_bf16 v[168:183], a[232:235], v[64:67], v[168:183]
    ds_read_b128 a[232:235], v4 offset:22528
    buffer_load_dwordx4 a[188:191], v247, s[44:47], s68 offen offset:2048 sc1
    v_mul_f32 v245, v245, v211
    v_exp_f32 v242, v242
    v_mul_f32_e64 v212, v212, v208
    v_mfma_f32_32x32x16_bf16 v[168:183], a[236:239], v[68:71], v[168:183]
    ds_read_b128 a[236:239], v4 offset:23552
    v_exp_f32 v243, v243
    v_mul_f32 v213, v213, v209
    v_exp_f32 v244, v244
    s_waitcnt lgkmcnt(4)
    v_mfma_f32_32x32x16_bf16 v[168:183], a[240:243], v[72:75], v[168:183]
    ds_read_b128 a[240:243], v4 offset:24576
    buffer_load_dwordx4 a[192:195], v247, s[44:47], s68 offen offset:3072 sc1
    v_mul_f32 v214, v214, v210
    v_exp_f32 v245, v245
    v_mfma_f32_32x32x16_bf16 v[168:183], a[244:247], v[76:79], v[168:183]
    ds_read_b128 a[244:247], v4 offset:25600
    v_mul_f32_e64 v215, v215, v211
    v_fma_f32 v242, v242, v234, v234
    v_fma_f32 v243, v243, v234, v234
    v_fma_f32 v244, v244, v234, v234
    v_fma_f32 v245, v245, v234, v234
    v_mfma_f32_32x32x16_bf16 v[168:183], a[248:251], v[80:83], v[168:183]
    ds_read_b128 a[248:251], v4 offset:26624
    v_rcp_f32 v242, v242
    v_rcp_f32 v243, v243
    v_rcp_f32_e64 v244, v244
    v_mfma_f32_32x32x16_bf16 v[168:183], a[252:255], v[84:87], v[168:183]
    ds_read_b128 a[252:255], v4 offset:27648
    buffer_load_dwordx4 a[196:199], v255, s[44:47], s68 offen offset:0 sc1
    v_rcp_f32_e64 v245, v245
    v_mul_f32 v212, v212, v242
    s_waitcnt lgkmcnt(4)
    v_mfma_f32_32x32x16_bf16 v[168:183], a[224:227], v[88:91], v[168:183]
    ds_read_b128 a[224:227], v4 offset:28672
    v_mul_f32 v213, v213, v243
    v_mul_f32 v214, v214, v244
    v_mul_f32_e64 v215, v215, v245
    v_cvt_pk_bf16_f32 v202, v212, v213
    v_cvt_pk_bf16_f32 v203, v214, v215
    v_mfma_f32_32x32x16_bf16 v[168:183], a[228:231], v[92:95], v[168:183]
    ds_read_b128 a[228:231], v4 offset:29696
    buffer_store_dwordx4 v[200:203], v2, s[44:47], s57 offen offset:2048 sc1
    v_mul_f32_e64 v242, v216, v216
    v_mfma_f32_32x32x16_bf16 v[168:183], a[232:235], v[96:99], v[168:183]
    ds_read_b128 a[232:235], v4 offset:30720
    s_mov_b32 s68, 2138112
    buffer_load_dwordx4 a[200:203], v247, s[44:47], s68 offen offset:0 sc1
    s_waitcnt vmcnt(10)
    s_mov_b64 exec, 1
    buffer_atomic_add v248, off, s[44:47], s54 sc1
    s_nop 0
    s_mov_b64 exec, -1
    s_add_u32 s54, s54, 2048
    v_mfma_f32_32x32x16_bf16 v[168:183], a[236:239], v[100:103], v[168:183]
    ds_read_b128 a[236:239], v4 offset:31744
    v_mul_f32 v243, v217, v217
    v_mul_f32 v244, v218, v218
    v_mul_f32 v245, v219, v219
    v_fma_f32 v242, v242, v233, v232
    s_waitcnt lgkmcnt(4)
    v_mfma_f32_32x32x16_bf16 v[168:183], a[240:243], v[104:107], v[168:183]
    ds_read_b128 a[240:243], v4 offset:32768
    buffer_load_dwordx4 a[204:207], v247, s[44:47], s68 offen offset:1024 sc1
    v_fma_f32 v243, v243, v233, v232
    v_fma_f32 v244, v244, v233, v232
    v_fma_f32 v245, v245, v233, v232
    v_mul_f32_e64 v242, v242, v216
    v_mfma_f32_32x32x16_bf16 v[168:183], a[244:247], v[108:111], v[168:183]
    ds_read_b128 a[244:247], v4 offset:33792
    v_mul_f32 v243, v243, v217
    v_mul_f32 v244, v244, v218
    v_mul_f32 v245, v245, v219
    v_exp_f32 v242, v242
    v_mfma_f32_32x32x16_bf16 v[168:183], a[248:251], v[112:115], v[168:183]
    ds_read_b128 a[248:251], v4 offset:34816
    v_and_b32 v1, 15, v0
    v_mul_f32 v220, v220, v216
    v_exp_f32 v243, v243
    v_mul_f32 v221, v221, v217
    v_mfma_f32_32x32x16_bf16 v[168:183], a[252:255], v[116:119], v[168:183]
    ds_read_b128 a[252:255], v4 offset:35840
    v_lshl_add_u32 v246, v1, 4, s20
    buffer_load_dwordx4 a[208:211], v247, s[44:47], s68 offen offset:2048 sc1
    v_exp_f32 v244, v244
    s_waitcnt lgkmcnt(4)
    v_mfma_f32_32x32x16_bf16 v[168:183], a[224:227], v[120:123], v[168:183]
    s_branch .Lover_4
.Lpad_4:
    s_setpc_b64 s[48:49]
.Lover_4:
    ds_read_b128 a[224:227], v4 offset:36864
    v_lshrrev_b32 v1, 4, v0
    v_mul_f32 v222, v222, v218
    v_exp_f32 v245, v245
    v_mul_f32 v223, v223, v219
    v_fma_f32 v242, v242, v234, v234
    v_mfma_f32_32x32x16_bf16 v[168:183], a[228:231], v[124:127], v[168:183]
    ds_read_b128 a[228:231], v4 offset:37888
    v_mad_u32_u24 v246, v1, s22, v246
    v_fma_f32 v243, v243, v234, v234
    v_fma_f32 v244, v244, v234, v234
    v_fma_f32 v245, v245, v234, v234
    v_mfma_f32_32x32x16_bf16 v[168:183], a[232:235], v[128:131], v[168:183]
    ds_read_b128 a[232:235], v4 offset:38912
    v_mad_u32_u24 v1, v1, s22, v246
    buffer_load_dwordx4 a[212:215], v247, s[44:47], s68 offen offset:3072 sc1
    v_rcp_f32_e64 v242, v242
    v_mfma_f32_32x32x16_bf16 v[168:183], a[236:239], v[132:135], v[168:183]
    ds_read_b128 a[236:239], v4 offset:39936
    v_rcp_f32_e64 v243, v243
    v_rcp_f32 v244, v244
    s_waitcnt lgkmcnt(4)
    v_mfma_f32_32x32x16_bf16 v[168:183], a[240:243], v[136:139], v[168:183]
    ds_read_b128 a[240:243], v5 offset:0
    buffer_load_dwordx4 a[216:219], v255, s[44:47], s68 offen offset:0 sc1
    v_rcp_f32 v245, v245
    v_mul_f32 v220, v220, v242
    v_mul_f32_e64 v221, v221, v243
    v_mfma_f32_32x32x16_bf16 v[168:183], a[244:247], v[140:143], v[168:183]
    ds_read_b128 a[244:247], v5 offset:1024
    v_add_u32 v252, s9, v3
    v_mul_f32 v222, v222, v244
    v_mul_f32_e64 v223, v223, v245
    v_cvt_pk_bf16_f32 v216, v220, v221
    v_cvt_pk_bf16_f32 v217, v222, v223
    v_mul_f32_e64 v242, v224, v224
    v_mfma_f32_32x32x16_bf16 v[168:183], a[248:251], v[144:147], v[168:183]
    ds_read_b128 a[248:251], v5 offset:2048
    v_add_u32 v253, s10, v3
    v_mul_f32 v243, v225, v225
    v_mul_f32 v244, v226, v226
    v_mul_f32 v245, v227, v227
    v_fma_f32 v242, v242, v233, v232
    v_mfma_f32_32x32x16_bf16 v[168:183], a[252:255], v[148:151], v[168:183]
    ds_read_b128 a[252:255], v5 offset:3072
    v_add_u32_e64 v251, s11, v3
    s_mov_b32 s68, 2143232
    buffer_load_dwordx4 a[220:223], v247, s[44:47], s68 offen offset:0 sc1
    v_fma_f32 v243, v243, v233, v232
    s_waitcnt lgkmcnt(4)
    v_mfma_f32_32x32x16_bf16 v[168:183], a[224:227], v[152:155], v[168:183]
    ds_read_b128 a[224:227], v5 offset:4096
    v_add_u32 v3, s8, v3
    v_fma_f32 v244, v244, v233, v232
    v_fma_f32 v245, v245, v233, v232
    v_mul_f32 v242, v242, v224
    v_mul_f32 v243, v243, v225
    v_mfma_f32_32x32x16_bf16 v[168:183], a[228:231], v[156:159], v[168:183]
    ds_read_b128 a[228:231], v5 offset:5120
    v_mul_f32 v244, v244, v226
    v_mul_f32 v245, v245, v227
    v_exp_f32 v242, v242
    v_mul_f32 v228, v228, v224
    v_mfma_f32_32x32x16_bf16 v[168:183], a[232:235], v[160:163], v[168:183]
    ds_read_b128 a[232:235], v5 offset:6144
    v_exp_f32 v243, v243
    v_mul_f32 v229, v229, v225
    v_exp_f32 v244, v244
    v_mul_f32 v230, v230, v226
    v_mfma_f32_32x32x16_bf16 v[168:183], a[236:239], v[164:167], v[168:183]
    ds_read_b128 a[236:239], v5 offset:7168
    v_exp_f32 v245, v245
    v_mul_f32 v231, v231, v227
    v_fma_f32 v242, v242, v234, v234
    v_fma_f32 v243, v243, v234, v234
    v_mfma_f32_32x32x16_bf16 v[184:199], a[156:159], v[236:239], 0
    v_fma_f32 v244, v244, v234, v234
    v_fma_f32 v245, v245, v234, v234
    v_rcp_f32_e64 v242, v242
    v_rcp_f32 v243, v243
    s_waitcnt lgkmcnt(4)
    v_mfma_f32_32x32x16_bf16 v[184:199], a[240:243], v[8:11], v[184:199]
    ds_read_b128 a[240:243], v5 offset:8192
    v_rcp_f32 v244, v244
    v_rcp_f32 v245, v245
    v_mul_f32_e64 v228, v228, v242
    v_mfma_f32_32x32x16_bf16 v[184:199], a[244:247], v[12:15], v[184:199]
    ds_read_b128 a[244:247], v5 offset:9216
    s_mov_b32 s66, 2153472
    buffer_load_dwordx4 a[156:159], v255, s[44:47], s66 offen offset:0 sc1
    v_mul_f32 v229, v229, v243
    v_mul_f32 v230, v230, v244
    v_mul_f32_e64 v231, v231, v245
    v_mfma_f32_32x32x16_bf16 v[184:199], a[248:251], v[16:19], v[184:199]
    ds_read_b128 a[248:251], v5 offset:10240
    v_cvt_pk_bf16_f32 v218, v228, v229
    v_cvt_pk_bf16_f32 v219, v230, v231
    buffer_store_dwordx4 v[216:219], v2, s[44:47], s57 offen offset:3072 sc1
    v_mfma_f32_32x32x16_bf16 v[184:199], a[252:255], v[20:23], v[184:199]
    ds_read_b128 a[252:255], v5 offset:11264
    v_mul_f32 v242, v168, v168
    v_mul_f32 v243, v169, v169
    v_mul_f32 v244, v170, v170
    s_waitcnt lgkmcnt(4)
    v_mfma_f32_32x32x16_bf16 v[184:199], a[224:227], v[24:27], v[184:199]
    ds_read_b128 a[224:227], v5 offset:12288
    v_mul_f32_e64 v245, v171, v171
    v_fma_f32 v242, v242, v233, v232
    v_fma_f32 v243, v243, v233, v232
    v_fma_f32 v244, v244, v233, v232
    v_fma_f32 v245, v245, v233, v232
    v_mfma_f32_32x32x16_bf16 v[184:199], a[228:231], v[28:31], v[184:199]
    ds_read_b128 a[228:231], v5 offset:13312
    v_mul_f32 v242, v242, v168
    v_mul_f32 v243, v243, v169
    v_mul_f32 v244, v244, v170
    v_mul_f32 v245, v245, v171
    v_exp_f32_e64 v242, v242
    v_mfma_f32_32x32x16_bf16 v[184:199], a[232:235], v[32:35], v[184:199]
    ds_read_b128 a[232:235], v5 offset:14336
    s_load_dword s71, s[44:45], s53
    s_mov_b32 s66, 0
    buffer_load_dwordx2 v[200:201], v1, s[44:47], s66 offen sc1
    v_mul_f32 v172, v172, v168
    v_mfma_f32_32x32x16_bf16 v[184:199], a[236:239], v[36:39], v[184:199]
    ds_read_b128 a[236:239], v5 offset:15360
    v_exp_f32 v243, v243
    v_mul_f32 v173, v173, v169
    v_exp_f32 v244, v244
    s_waitcnt lgkmcnt(4)
    v_mfma_f32_32x32x16_bf16 v[184:199], a[240:243], v[40:43], v[184:199]
    ds_read_b128 a[240:243], v5 offset:16384
    s_mov_b32 s66, 16384
    buffer_load_dwordx2 v[202:203], v1, s[44:47], s66 offen sc1
    v_mul_f32 v174, v174, v170
    v_exp_f32 v245, v245
    v_mfma_f32_32x32x16_bf16 v[184:199], a[244:247], v[44:47], v[184:199]
    ds_read_b128 a[244:247], v5 offset:17408
    v_mul_f32_e64 v175, v175, v171
    v_fma_f32 v242, v242, v234, v234
    v_fma_f32 v243, v243, v234, v234
    v_fma_f32 v244, v244, v234, v234
    v_fma_f32 v245, v245, v234, v234
    v_mfma_f32_32x32x16_bf16 v[184:199], a[248:251], v[48:51], v[184:199]
    ds_read_b128 a[248:251], v5 offset:18432
    s_mov_b32 s66, 131072
    buffer_load_dwordx2 v[204:205], v1, s[44:47], s66 offen sc1
    v_rcp_f32_e64 v242, v242
    v_mfma_f32_32x32x16_bf16 v[184:199], a[252:255], v[52:55], v[184:199]
    ds_read_b128 a[252:255], v5 offset:19456
    v_rcp_f32_e64 v243, v243
    v_rcp_f32 v244, v244
    s_waitcnt lgkmcnt(4)
    v_mfma_f32_32x32x16_bf16 v[184:199], a[224:227], v[56:59], v[184:199]
    ds_read_b128 a[224:227], v5 offset:20480
    s_mov_b32 s66, 147456
    buffer_load_dwordx2 v[206:207], v1, s[44:47], s66 offen sc1
    v_rcp_f32 v245, v245
    v_mul_f32 v172, v172, v242
    v_mfma_f32_32x32x16_bf16 v[184:199], a[228:231], v[60:63], v[184:199]
    ds_read_b128 a[228:231], v5 offset:21504
    v_mul_f32 v173, v173, v243
    v_mul_f32 v174, v174, v244
    v_mul_f32_e64 v175, v175, v245
    v_cvt_pk_bf16_f32 v168, v172, v173
    v_cvt_pk_bf16_f32 v169, v174, v175
    v_mul_f32_e64 v242, v176, v176
    v_mfma_f32_32x32x16_bf16 v[184:199], a[232:235], v[64:67], v[184:199]
    ds_read_b128 a[232:235], v5 offset:22528
    s_mov_b32 s66, 262144
    buffer_load_dwordx2 v[208:209], v246, s[44:47], s66 offen sc1
    v_mul_f32 v243, v177, v177
    v_mul_f32 v244, v178, v178
    v_mfma_f32_32x32x16_bf16 v[184:199], a[236:239], v[68:71], v[184:199]
    ds_read_b128 a[236:239], v5 offset:23552
    v_mul_f32_e64 v245, v179, v179
    v_fma_f32 v242, v242, v233, v232
    v_fma_f32 v243, v243, v233, v232
    v_fma_f32 v244, v244, v233, v232
    v_fma_f32 v245, v245, v233, v232
    s_waitcnt lgkmcnt(4)
    v_mfma_f32_32x32x16_bf16 v[184:199], a[240:243], v[72:75], v[184:199]
    ds_read_b128 a[240:243], v5 offset:24576
    v_mul_f32 v242, v242, v176
    v_mul_f32 v243, v243, v177
    v_mul_f32 v244, v244, v178
    v_mul_f32_e64 v245, v245, v179
    v_mfma_f32_32x32x16_bf16 v[184:199], a[244:247], v[76:79], v[184:199]
    ds_read_b128 a[244:247], v5 offset:25600
    v_exp_f32 v242, v242
    v_mul_f32 v180, v180, v176
    v_exp_f32 v243, v243
    v_mul_f32 v181, v181, v177
    v_mfma_f32_32x32x16_bf16 v[184:199], a[248:251], v[80:83], v[184:199]
    ds_read_b128 a[248:251], v5 offset:26624
    v_exp_f32 v244, v244
    v_mul_f32 v182, v182, v178
    v_exp_f32 v245, v245
    v_mul_f32 v183, v183, v179
    v_mfma_f32_32x32x16_bf16 v[184:199], a[252:255], v[84:87], v[184:199]
    ds_read_b128 a[252:255], v5 offset:27648
    v_fma_f32 v242, v242, v234, v234
    v_fma_f32 v243, v243, v234, v234
    v_fma_f32 v244, v244, v234, v234
    v_fma_f32 v245, v245, v234, v234
    s_waitcnt lgkmcnt(4)
    v_mfma_f32_32x32x16_bf16 v[184:199], a[224:227], v[88:91], v[184:199]
    ds_read_b128 a[224:227], v5 offset:28672
    v_rcp_f32 v242, v242
    v_rcp_f32 v243, v243
    v_rcp_f32 v244, v244
    v_mfma_f32_32x32x16_bf16 v[184:199], a[228:231], v[92:95], v[184:199]
    ds_read_b128 a[228:231], v5 offset:29696
    v_rcp_f32 v245, v245
    v_mul_f32 v180, v180, v242
    v_mul_f32 v181, v181, v243
    v_mul_f32 v182, v182, v244
    v_mfma_f32_32x32x16_bf16 v[184:199], a[232:235], v[96:99], v[184:199]
    ds_read_b128 a[232:235], v5 offset:30720
    v_mul_f32_e64 v183, v183, v245
    v_cvt_pk_bf16_f32 v170, v180, v181
    v_cvt_pk_bf16_f32 v171, v182, v183
    buffer_store_dwordx4 v[168:171], v2, s[44:47], s58 offen offset:0 sc1
    v_mfma_f32_32x32x16_bf16 v[184:199], a[236:239], v[100:103], v[184:199]
    ds_read_b128 a[236:239], v5 offset:31744
    s_waitcnt lgkmcnt(4)
    v_mfma_f32_32x32x16_bf16 v[184:199], a[240:243], v[104:107], v[184:199]
    ds_read_b128 a[240:243], v5 offset:32768
    s_waitcnt vmcnt(6)
    s_mov_b64 exec, 1
    buffer_atomic_add v248, off, s[44:47], s54 sc1
    s_mov_b64 exec, -1
    s_add_u32 s54, s54, 2048
    v_mfma_f32_32x32x16_bf16 v[184:199], a[244:247], v[108:111], v[184:199]
    ds_read_b128 a[244:247], v5 offset:33792
    s_waitcnt lgkmcnt(0)
    s_mov_b32 s67, s71
    s_cmp_lt_u32 s67, 32
    s_cbranch_scc1 .Lslow_25
.Lback_26:
    s_add_u32 s53, s53, 2048
    v_mfma_f32_32x32x16_bf16 v[184:199], a[248:251], v[112:115], v[184:199]
    ds_read_b128 a[248:251], v5 offset:34816
    buffer_load_dwordx4 v[8:11], v251, s[44:47], s24 offen offset:0 sc1
    v_mfma_f32_32x32x16_bf16 v[184:199], a[252:255], v[116:119], v[184:199]
    ds_read_b128 a[252:255], v5 offset:35840
    v_mfma_f32_32x32x16_bf16 v[184:199], a[224:227], v[120:123], v[184:199]
    ds_read_b128 a[224:227], v5 offset:36864
    buffer_load_dwordx4 v[12:15], v251, s[44:47], s26 offen offset:0 sc1
    v_mfma_f32_32x32x16_bf16 v[184:199], a[228:231], v[124:127], v[184:199]
    ds_read_b128 a[228:231], v5 offset:37888
    v_mfma_f32_32x32x16_bf16 v[184:199], a[232:235], v[128:131], v[184:199]
    ds_read_b128 a[232:235], v5 offset:38912
    buffer_load_dwordx4 v[16:19], v251, s[44:47], s27 offen offset:0 sc1
    v_mfma_f32_32x32x16_bf16 v[184:199], a[236:239], v[132:135], v[184:199]
    ds_read_b128 a[236:239], v5 offset:39936
    s_nop 0
    s_waitcnt lgkmcnt(4)
    v_mfma_f32_32x32x16_bf16 v[184:199], a[240:243], v[136:139], v[184:199]
    buffer_load_dwordx4 v[20:23], v251, s[44:47], s29 offen offset:0 sc1
    v_mfma_f32_32x32x16_bf16 v[184:199], a[244:247], v[140:143], v[184:199]
    v_mfma_f32_32x32x16_bf16 v[184:199], a[248:251], v[144:147], v[184:199]
    buffer_load_dwordx4 v[24:27], v253, s[44:47], s24 offen offset:0 sc1
    v_mfma_f32_32x32x16_bf16 v[184:199], a[252:255], v[148:151], v[184:199]
    s_nop 0
    s_waitcnt lgkmcnt(0)
    v_mfma_f32_32x32x16_bf16 v[184:199], a[224:227], v[152:155], v[184:199]
    buffer_load_dwordx4 v[28:31], v253, s[44:47], s26 offen offset:0 sc1
    v_mfma_f32_32x32x16_bf16 v[184:199], a[228:231], v[156:159], v[184:199]
    v_mfma_f32_32x32x16_bf16 v[184:199], a[232:235], v[160:163], v[184:199]
    buffer_load_dwordx4 v[32:35], v253, s[44:47], s27 offen offset:0 sc1
    v_mfma_f32_32x32x16_bf16 v[184:199], a[236:239], v[164:167], v[184:199]
    s_mov_b32 s60, 0xffff0000
    s_waitcnt vmcnt(13)
    v_lshlrev_b32 v72, 16, v200
    v_and_b32 v73, s60, v200
    v_lshlrev_b32 v74, 16, v201
    v_and_b32 v75, s60, v201
    s_waitcnt vmcnt(12)
    v_lshlrev_b32 v76, 16, v202
    v_and_b32 v77, s60, v202
    v_lshlrev_b32 v78, 16, v203
    v_and_b32 v79, s60, v203
    s_waitcnt vmcnt(11)
    v_lshlrev_b32 v80, 16, v204
    v_and_b32 v81, s60, v204
    v_lshlrev_b32 v82, 16, v205
    v_and_b32 v83, s60, v205
    s_waitcnt vmcnt(10)
    v_lshlrev_b32 v84, 16, v206
    v_and_b32 v85, s60, v206
    v_lshlrev_b32 v86, 16, v207
    v_and_b32 v87, s60, v207
    s_waitcnt vmcnt(9)
    v_lshlrev_b32 v88, 16, v208
    v_and_b32 v89, s60, v208
    v_lshlrev_b32 v90, 16, v209
    v_and_b32_e64 v91, s60, v209
    v_pk_mul_f32 v[242:243], v[184:185], v[184:185]
    v_pk_mul_f32 v[244:245], v[186:187], v[186:187]
    v_pk_fma_f32 v[242:243], v[242:243], v[232:233], v[232:233] op_sel:[0,1,0] op_sel_hi:[1,1,0]
    v_pk_fma_f32 v[244:245], v[244:245], v[232:233], v[232:233] op_sel:[0,1,0] op_sel_hi:[1,1,0]
    v_pk_mul_f32 v[188:189], v[188:189], v[184:185]
    v_pk_mul_f32 v[242:243], v[242:243], v[184:185]
    v_pk_mul_f32 v[244:245], v[244:245], v[186:187]
    v_exp_f32_e64 v242, v242
    buffer_load_dwordx4 v[36:39], v253, s[44:47], s29 offen offset:0 sc1
    v_exp_f32 v243, v243
    v_exp_f32 v244, v244
    v_exp_f32_e64 v245, v245
    v_pk_mul_f32 v[190:191], v[190:191], v[186:187]
    v_pk_fma_f32 v[242:243], v[242:243], v[234:235], v[234:235] op_sel:[0,0,0] op_sel_hi:[1,0,0]
    v_pk_fma_f32 v[244:245], v[244:245], v[234:235], v[234:235] op_sel:[0,0,0] op_sel_hi:[1,0,0]
    v_rcp_f32_e64 v242, v242
    buffer_load_dwordx4 v[40:43], v252, s[44:47], s24 offen offset:0 sc1
    v_rcp_f32 v243, v243
    v_rcp_f32 v244, v244
    v_rcp_f32_e64 v245, v245
    v_pk_mul_f32 v[188:189], v[188:189], v[242:243]
    v_pk_mul_f32 v[190:191], v[190:191], v[244:245]
    v_cvt_pk_bf16_f32 v184, v188, v189
    v_cvt_pk_bf16_f32 v185, v190, v191
    buffer_load_dwordx4 v[44:47], v252, s[44:47], s26 offen offset:0 sc1
    v_pk_mul_f32 v[242:243], v[192:193], v[192:193]
    v_pk_mul_f32 v[244:245], v[194:195], v[194:195]
    v_pk_fma_f32 v[242:243], v[242:243], v[232:233], v[232:233] op_sel:[0,1,0] op_sel_hi:[1,1,0]
    v_pk_fma_f32 v[244:245], v[244:245], v[232:233], v[232:233] op_sel:[0,1,0] op_sel_hi:[1,1,0]
    v_pk_mul_f32 v[196:197], v[196:197], v[192:193]
    v_pk_mul_f32 v[242:243], v[242:243], v[192:193]
    v_pk_mul_f32 v[244:245], v[244:245], v[194:195]
    v_exp_f32_e64 v242, v242
    buffer_load_dwordx4 v[48:51], v252, s[44:47], s27 offen offset:0 sc1
    v_exp_f32 v243, v243
    v_exp_f32 v244, v244
    v_exp_f32_e64 v245, v245
    v_pk_mul_f32 v[198:199], v[198:199], v[194:195]
    v_pk_fma_f32 v[242:243], v[242:243], v[234:235], v[234:235] op_sel:[0,0,0] op_sel_hi:[1,0,0]
    v_pk_fma_f32 v[244:245], v[244:245], v[234:235], v[234:235] op_sel:[0,0,0] op_sel_hi:[1,0,0]
    v_rcp_f32_e64 v242, v242
    buffer_load_dwordx4 v[52:55], v252, s[44:47], s29 offen offset:0 sc1
    v_rcp_f32 v243, v243
    v_rcp_f32 v244, v244
    v_rcp_f32_e64 v245, v245
    v_pk_mul_f32 v[196:197], v[196:197], v[242:243]
    v_pk_mul_f32 v[198:199], v[198:199], v[244:245]
    v_cvt_pk_bf16_f32 v186, v196, v197
    v_cvt_pk_bf16_f32 v187, v198, v199
    s_load_dword s71, s[44:45], s53
    buffer_store_dwordx4 v[184:187], v2, s[44:47], s58 offen offset:1024 sc1
    s_waitcnt vmcnt(12)
    v_mfma_f32_16x16x32_bf16 v[132:135], a[0:3], v[8:11], 0
    s_movk_i32 s66, 20320
    buffer_load_dwordx4 v[56:59], v3, s[44:47], s24 offen offset:0 sc1
    s_nop 0
    s_waitcnt vmcnt(12)
    v_mfma_f32_16x16x32_bf16 v[132:135], a[20:23], v[12:15], v[132:135]
    s_movk_i32 s65, 6554
    s_waitcnt vmcnt(11)
    v_mfma_f32_16x16x32_bf16 v[132:135], a[40:43], v[16:19], v[132:135]
    s_movk_i32 s64, 176
    s_waitcnt vmcnt(10)
    v_mfma_f32_16x16x32_bf16 v[132:135], a[60:63], v[20:23], v[132:135]
    s_mul_i32 s63, s3, 2816
    v_mfma_f32_16x16x32_bf16 v[136:139], a[4:7], v[8:11], 0
    v_and_b32_e64 v250, 15, v0
    v_mfma_f32_16x16x32_bf16 v[136:139], a[24:27], v[12:15], v[136:139]
    v_lshrrev_b32_e64 v249, 4, v0
    buffer_load_dwordx4 v[60:63], v3, s[44:47], s26 offen offset:0 sc1
    v_mfma_f32_16x16x32_bf16 v[136:139], a[44:47], v[16:19], v[136:139]
    v_mov_b32_e64 v239, s63
    v_mfma_f32_16x16x32_bf16 v[136:139], a[64:67], v[20:23], v[136:139]
    v_mad_u32_u24 v239, v250, s64, v239
    v_mfma_f32_16x16x32_bf16 v[140:143], a[8:11], v[8:11], 0
    v_lshl_add_u32 v238, v249, 4, v239
    v_mfma_f32_16x16x32_bf16 v[140:143], a[28:31], v[12:15], v[140:143]
    v_lshl_add_u32 v239, v249, 3, v239
    v_mfma_f32_16x16x32_bf16 v[140:143], a[48:51], v[16:19], v[140:143]
    v_mul_u32_u24_e64 v249, s65, v0
    buffer_load_dwordx4 v[64:67], v3, s[44:47], s27 offen offset:0 sc1
    v_mfma_f32_16x16x32_bf16 v[140:143], a[68:71], v[20:23], v[140:143]
    v_lshrrev_b32_e64 v249, 16, v249
    v_mfma_f32_16x16x32_bf16 v[144:147], a[12:15], v[8:11], 0
    v_lshl_add_u32 v4, v0, 4, s21
    v_mfma_f32_16x16x32_bf16 v[144:147], a[32:35], v[12:15], v[144:147]
    v_mad_u32_u24 v4, v249, s66, v4
    v_mfma_f32_16x16x32_bf16 v[144:147], a[52:55], v[16:19], v[144:147]
    v_add_u32_e64 v250, v0, v249
    v_mfma_f32_16x16x32_bf16 v[144:147], a[72:75], v[20:23], v[144:147]
    v_lshl_add_u32 v242, v250, 4, s63
    buffer_load_dwordx4 v[68:71], v3, s[44:47], s29 offen offset:0 sc1
    v_mfma_f32_16x16x32_bf16 v[148:151], a[16:19], v[8:11], 0
    s_mov_b32 s64, 122880
    v_mfma_f32_16x16x32_bf16 v[148:151], a[36:39], v[12:15], v[148:151]
    s_mov_b32 s65, 245760
    v_mfma_f32_16x16x32_bf16 v[148:151], a[56:59], v[16:19], v[148:151]
    s_xor_b32 s60, s3, 0
    v_mfma_f32_16x16x32_bf16 v[148:151], a[76:79], v[20:23], v[148:151]
    s_mul_i32 s60, s60, 15360
    s_waitcnt vmcnt(12)
    v_mfma_f32_16x16x32_bf16 v[112:115], a[0:3], v[24:27], 0
    s_add_u32 s60, s60, 81920
    s_waitcnt lgkmcnt(0)
    s_mov_b32 s67, s71
    s_cmp_lt_u32 s67, 32
    s_cbranch_scc1 .Lslow_27
.Lback_28:
    s_add_u32 s53, s53, 2048
    buffer_load_dwordx4 v[152:155], v251, s[44:47], s24 offen offset:2048 sc1
    s_waitcnt vmcnt(12)
    v_mfma_f32_16x16x32_bf16 v[112:115], a[20:23], v[28:31], v[112:115]
    v_lshl_add_u32 v7, v0, 4, s60
    s_waitcnt vmcnt(11)
    v_mfma_f32_16x16x32_bf16 v[112:115], a[40:43], v[32:35], v[112:115]
    s_xor_b32 s60, s3, 1
    s_waitcnt vmcnt(10)
    v_mfma_f32_16x16x32_bf16 v[112:115], a[60:63], v[36:39], v[112:115]
    s_mul_i32 s60, s60, 15360
    v_mfma_f32_16x16x32_bf16 v[116:119], a[4:7], v[24:27], 0
    s_add_u32 s60, s60, 81920
    v_mfma_f32_16x16x32_bf16 v[116:119], a[24:27], v[28:31], v[116:119]
    v_lshl_add_u32 v232, v0, 4, s60
    buffer_load_dwordx4 v[156:159], v251, s[44:47], s26 offen offset:2048 sc1
    v_mfma_f32_16x16x32_bf16 v[116:119], a[44:47], v[32:35], v[116:119]
    s_nop 0
    s_xor_b32 s60, s3, 2
    v_mfma_f32_16x16x32_bf16 v[116:119], a[64:67], v[36:39], v[116:119]
    s_mul_i32 s60, s60, 15360
    v_mfma_f32_16x16x32_bf16 v[120:123], a[8:11], v[24:27], 0
    s_add_u32 s60, s60, 87040
    v_mfma_f32_16x16x32_bf16 v[120:123], a[28:31], v[28:31], v[120:123]
    v_lshl_add_u32 v233, v0, 4, s60
    v_mfma_f32_16x16x32_bf16 v[120:123], a[48:51], v[32:35], v[120:123]
    s_nop 0
    s_xor_b32 s60, s3, 3
    buffer_load_dwordx4 v[160:163], v251, s[44:47], s27 offen offset:2048 sc1
    v_mfma_f32_16x16x32_bf16 v[120:123], a[68:71], v[36:39], v[120:123]
    s_mul_i32 s60, s60, 15360
    v_mfma_f32_16x16x32_bf16 v[124:127], a[12:15], v[24:27], 0
    s_add_u32 s60, s60, 92160
    v_mfma_f32_16x16x32_bf16 v[124:127], a[32:35], v[28:31], v[124:127]
    v_lshl_add_u32 v234, v0, 4, s60
    v_mfma_f32_16x16x32_bf16 v[124:127], a[52:55], v[32:35], v[124:127]
    v_mfma_f32_16x16x32_bf16 v[124:127], a[72:75], v[36:39], v[124:127]
    buffer_load_dwordx4 v[164:167], v251, s[44:47], s29 offen offset:2048 sc1
    v_mfma_f32_16x16x32_bf16 v[128:131], a[16:19], v[24:27], 0
    v_mfma_f32_16x16x32_bf16 v[128:131], a[36:39], v[28:31], v[128:131]
    v_mfma_f32_16x16x32_bf16 v[128:131], a[56:59], v[32:35], v[128:131]
    v_mfma_f32_16x16x32_bf16 v[128:131], a[76:79], v[36:39], v[128:131]
    s_nop 0
    s_waitcnt vmcnt(8)
    s_atomic_add s75, s[44:45], s54
    v_mfma_f32_16x16x32_bf16 v[92:95], a[0:3], v[40:43], 0
    buffer_load_dwordx4 v[200:203], v253, s[44:47], s24 offen offset:2048 sc1
    v_mfma_f32_16x16x32_bf16 v[92:95], a[20:23], v[44:47], v[92:95]
    v_mfma_f32_16x16x32_bf16 v[92:95], a[40:43], v[48:51], v[92:95]
    v_mfma_f32_16x16x32_bf16 v[92:95], a[60:63], v[52:55], v[92:95]
    v_mfma_f32_16x16x32_bf16 v[96:99], a[4:7], v[40:43], 0
    v_mfma_f32_16x16x32_bf16 v[96:99], a[24:27], v[44:47], v[96:99]
    buffer_load_dwordx4 v[204:207], v253, s[44:47], s26 offen offset:2048 sc1
    v_mfma_f32_16x16x32_bf16 v[96:99], a[44:47], v[48:51], v[96:99]
    v_mfma_f32_16x16x32_bf16 v[96:99], a[64:67], v[52:55], v[96:99]
    v_mfma_f32_16x16x32_bf16 v[100:103], a[8:11], v[40:43], 0
    v_mfma_f32_16x16x32_bf16 v[100:103], a[28:31], v[44:47], v[100:103]
    v_mfma_f32_16x16x32_bf16 v[100:103], a[48:51], v[48:51], v[100:103]
    buffer_load_dwordx4 v[208:211], v253, s[44:47], s27 offen offset:2048 sc1
    v_mfma_f32_16x16x32_bf16 v[100:103], a[68:71], v[52:55], v[100:103]
    v_mfma_f32_16x16x32_bf16 v[104:107], a[12:15], v[40:43], 0
    v_mfma_f32_16x16x32_bf16 v[104:107], a[32:35], v[44:47], v[104:107]
    v_mfma_f32_16x16x32_bf16 v[104:107], a[52:55], v[48:51], v[104:107]
    v_mfma_f32_16x16x32_bf16 v[104:107], a[72:75], v[52:55], v[104:107]
    buffer_load_dwordx4 v[212:215], v253, s[44:47], s29 offen offset:2048 sc1
    v_mfma_f32_16x16x32_bf16 v[108:111], a[16:19], v[40:43], 0
    v_mfma_f32_16x16x32_bf16 v[108:111], a[36:39], v[44:47], v[108:111]
    v_mfma_f32_16x16x32_bf16 v[108:111], a[56:59], v[48:51], v[108:111]
    v_mfma_f32_16x16x32_bf16 v[108:111], a[76:79], v[52:55], v[108:111]
    s_waitcnt vmcnt(11)
    v_mfma_f32_16x16x32_bf16 v[72:75], a[0:3], v[56:59], v[72:75]
    buffer_load_dwordx4 v[216:219], v252, s[44:47], s24 offen offset:2048 sc1
    s_waitcnt vmcnt(11)
    v_mfma_f32_16x16x32_bf16 v[72:75], a[20:23], v[60:63], v[72:75]
    s_waitcnt vmcnt(10)
    v_mfma_f32_16x16x32_bf16 v[72:75], a[40:43], v[64:67], v[72:75]
    s_waitcnt vmcnt(9)
    v_mfma_f32_16x16x32_bf16 v[72:75], a[60:63], v[68:71], v[72:75]
    v_mfma_f32_16x16x32_bf16 v[76:79], a[4:7], v[56:59], v[76:79]
    v_mfma_f32_16x16x32_bf16 v[76:79], a[24:27], v[60:63], v[76:79]
    buffer_load_dwordx4 v[220:223], v252, s[44:47], s26 offen offset:2048 sc1
    v_mfma_f32_16x16x32_bf16 v[76:79], a[44:47], v[64:67], v[76:79]
    v_mfma_f32_16x16x32_bf16 v[76:79], a[64:67], v[68:71], v[76:79]
    v_mfma_f32_16x16x32_bf16 v[80:83], a[8:11], v[56:59], v[80:83]
    v_mfma_f32_16x16x32_bf16 v[80:83], a[28:31], v[60:63], v[80:83]
    v_mfma_f32_16x16x32_bf16 v[80:83], a[48:51], v[64:67], v[80:83]
    buffer_load_dwordx4 v[224:227], v252, s[44:47], s27 offen offset:2048 sc1
    v_mfma_f32_16x16x32_bf16 v[80:83], a[68:71], v[68:71], v[80:83]
    v_mfma_f32_16x16x32_bf16 v[84:87], a[12:15], v[56:59], v[84:87]
    v_mfma_f32_16x16x32_bf16 v[84:87], a[32:35], v[60:63], v[84:87]
    v_mfma_f32_16x16x32_bf16 v[84:87], a[52:55], v[64:67], v[84:87]
    v_mfma_f32_16x16x32_bf16 v[84:87], a[72:75], v[68:71], v[84:87]
    buffer_load_dwordx4 v[228:231], v252, s[44:47], s29 offen offset:2048 sc1
    v_mfma_f32_16x16x32_bf16 v[88:91], a[16:19], v[56:59], v[88:91]
    v_mfma_f32_16x16x32_bf16 v[88:91], a[36:39], v[60:63], v[88:91]
    v_mfma_f32_16x16x32_bf16 v[88:91], a[56:59], v[64:67], v[88:91]
    v_mfma_f32_16x16x32_bf16 v[88:91], a[76:79], v[68:71], v[88:91]
    s_waitcnt vmcnt(11)
    v_mfma_f32_16x16x32_bf16 v[132:135], a[80:83], v[152:155], v[132:135]
    buffer_load_dwordx4 v[168:171], v3, s[44:47], s24 offen offset:2048 sc1
    s_waitcnt vmcnt(11)
    v_mfma_f32_16x16x32_bf16 v[132:135], a[100:103], v[156:159], v[132:135]
    s_waitcnt vmcnt(10)
    v_mfma_f32_16x16x32_bf16 v[132:135], a[120:123], v[160:163], v[132:135]
    buffer_load_dwordx4 a[224:227], v247, s[44:47], s68 offen offset:1024 sc1
    s_waitcnt vmcnt(10)
    v_mfma_f32_16x16x32_bf16 v[132:135], a[140:143], v[164:167], v[132:135]
    v_mfma_f32_16x16x32_bf16 v[136:139], a[84:87], v[152:155], v[136:139]
    v_mfma_f32_16x16x32_bf16 v[136:139], a[104:107], v[156:159], v[136:139]
    buffer_load_dwordx4 v[172:175], v3, s[44:47], s26 offen offset:2048 sc1
    v_mfma_f32_16x16x32_bf16 v[136:139], a[124:127], v[160:163], v[136:139]
    v_mfma_f32_16x16x32_bf16 v[136:139], a[144:147], v[164:167], v[136:139]
    buffer_load_dwordx4 a[228:231], v247, s[44:47], s68 offen offset:2048 sc1
    v_mfma_f32_16x16x32_bf16 v[140:143], a[88:91], v[152:155], v[140:143]
    v_mfma_f32_16x16x32_bf16 v[140:143], a[108:111], v[156:159], v[140:143]
    v_mfma_f32_16x16x32_bf16 v[140:143], a[128:131], v[160:163], v[140:143]
    buffer_load_dwordx4 v[176:179], v3, s[44:47], s27 offen offset:2048 sc1
    v_mfma_f32_16x16x32_bf16 v[140:143], a[148:151], v[164:167], v[140:143]
    v_mfma_f32_16x16x32_bf16 v[144:147], a[92:95], v[152:155], v[144:147]
    buffer_load_dwordx4 a[232:235], v247, s[44:47], s68 offen offset:3072 sc1
    v_mfma_f32_16x16x32_bf16 v[144:147], a[112:115], v[156:159], v[144:147]
    v_mfma_f32_16x16x32_bf16 v[144:147], a[132:135], v[160:163], v[144:147]
    v_mfma_f32_16x16x32_bf16 v[144:147], a[152:155], v[164:167], v[144:147]
    buffer_load_dwordx4 v[180:183], v3, s[44:47], s29 offen offset:2048 sc1
    v_mfma_f32_16x16x32_bf16 v[148:151], a[96:99], v[152:155], v[148:151]
    v_mfma_f32_16x16x32_bf16 v[148:151], a[116:119], v[156:159], v[148:151]
    buffer_load_dwordx4 a[236:239], v255, s[44:47], s68 offen offset:0 sc1
    v_mfma_f32_16x16x32_bf16 v[148:151], a[136:139], v[160:163], v[148:151]
    v_mfma_f32_16x16x32_bf16 v[148:151], a[156:159], v[164:167], v[148:151]
    s_waitcnt vmcnt(15)
    v_mfma_f32_16x16x32_bf16 v[112:115], a[80:83], v[200:203], v[112:115]
    s_waitcnt vmcnt(14)
    v_mfma_f32_16x16x32_bf16 v[112:115], a[100:103], v[204:207], v[112:115]
    s_waitcnt vmcnt(13)
    v_mfma_f32_16x16x32_bf16 v[112:115], a[120:123], v[208:211], v[112:115]
    s_waitcnt vmcnt(12)
    v_mfma_f32_16x16x32_bf16 v[112:115], a[140:143], v[212:215], v[112:115]
    v_mfma_f32_16x16x32_bf16 v[116:119], a[84:87], v[200:203], v[116:119]
    s_load_dword s71, s[44:45], s53
    v_mfma_f32_16x16x32_bf16 v[116:119], a[104:107], v[204:207], v[116:119]
    v_mfma_f32_16x16x32_bf16 v[116:119], a[124:127], v[208:211], v[116:119]
    v_mfma_f32_16x16x32_bf16 v[116:119], a[144:147], v[212:215], v[116:119]
    v_mfma_f32_16x16x32_bf16 v[120:123], a[88:91], v[200:203], v[120:123]
    v_mfma_f32_16x16x32_bf16 v[120:123], a[108:111], v[204:207], v[120:123]
    v_mfma_f32_16x16x32_bf16 v[120:123], a[128:131], v[208:211], v[120:123]
    v_mfma_f32_16x16x32_bf16 v[120:123], a[148:151], v[212:215], v[120:123]
    v_mfma_f32_16x16x32_bf16 v[124:127], a[92:95], v[200:203], v[124:127]
    v_mfma_f32_16x16x32_bf16 v[124:127], a[112:115], v[204:207], v[124:127]
    v_mfma_f32_16x16x32_bf16 v[124:127], a[132:135], v[208:211], v[124:127]
    v_mfma_f32_16x16x32_bf16 v[124:127], a[152:155], v[212:215], v[124:127]
    v_mfma_f32_16x16x32_bf16 v[128:131], a[96:99], v[200:203], v[128:131]
    v_mfma_f32_16x16x32_bf16 v[128:131], a[116:119], v[204:207], v[128:131]
    v_mfma_f32_16x16x32_bf16 v[128:131], a[136:139], v[208:211], v[128:131]
    s_waitcnt lgkmcnt(0)
    s_mov_b32 s67, s71
    s_cmp_lt_u32 s67, 32
    s_cbranch_scc1 .Lslow_29
.Lback_30:
    buffer_load_dwordx4 v[8:11], v251, s[44:47], s25 offen offset:0 sc1
    v_mfma_f32_16x16x32_bf16 v[128:131], a[156:159], v[212:215], v[128:131]
    s_waitcnt vmcnt(12)
    v_mfma_f32_16x16x32_bf16 v[92:95], a[80:83], v[216:219], v[92:95]
    buffer_load_dwordx4 v[12:15], v251, s[44:47], s25 offen offset:2048 sc1
    s_waitcnt vmcnt(12)
    v_mfma_f32_16x16x32_bf16 v[92:95], a[100:103], v[220:223], v[92:95]
    s_waitcnt vmcnt(11)
    v_mfma_f32_16x16x32_bf16 v[92:95], a[120:123], v[224:227], v[92:95]
    buffer_load_dwordx4 v[16:19], v251, s[44:47], s28 offen offset:0 sc1
    s_waitcnt vmcnt(11)
    v_mfma_f32_16x16x32_bf16 v[92:95], a[140:143], v[228:231], v[92:95]
    v_mfma_f32_16x16x32_bf16 v[96:99], a[84:87], v[216:219], v[96:99]
    buffer_load_dwordx4 v[20:23], v251, s[44:47], s28 offen offset:2048 sc1
    v_mfma_f32_16x16x32_bf16 v[96:99], a[104:107], v[220:223], v[96:99]
    v_mfma_f32_16x16x32_bf16 v[96:99], a[124:127], v[224:227], v[96:99]
    buffer_load_dwordx4 v[24:27], v253, s[44:47], s25 offen offset:0 sc1
    v_mfma_f32_16x16x32_bf16 v[96:99], a[144:147], v[228:231], v[96:99]
    v_mfma_f32_16x16x32_bf16 v[100:103], a[88:91], v[216:219], v[100:103]
    buffer_load_dwordx4 v[28:31], v253, s[44:47], s25 offen offset:2048 sc1
    v_mfma_f32_16x16x32_bf16 v[100:103], a[108:111], v[220:223], v[100:103]
    v_mfma_f32_16x16x32_bf16 v[100:103], a[128:131], v[224:227], v[100:103]
    buffer_load_dwordx4 v[32:35], v253, s[44:47], s28 offen offset:0 sc1
    v_mfma_f32_16x16x32_bf16 v[100:103], a[148:151], v[228:231], v[100:103]
    v_mfma_f32_16x16x32_bf16 v[104:107], a[92:95], v[216:219], v[104:107]
    v_mfma_f32_16x16x32_bf16 v[104:107], a[112:115], v[220:223], v[104:107]
    v_mfma_f32_16x16x32_bf16 v[104:107], a[132:135], v[224:227], v[104:107]
    v_mfma_f32_16x16x32_bf16 v[104:107], a[152:155], v[228:231], v[104:107]
    buffer_load_dwordx4 v[36:39], v253, s[44:47], s28 offen offset:2048 sc1
    v_mfma_f32_16x16x32_bf16 v[108:111], a[96:99], v[216:219], v[108:111]
    s_branch .Lover_5
.Lpad_5:
    s_setpc_b64 s[48:49]
.Lover_5:
    v_mfma_f32_16x16x32_bf16 v[108:111], a[116:119], v[220:223], v[108:111]
    v_mfma_f32_16x16x32_bf16 v[108:111], a[136:139], v[224:227], v[108:111]
    v_mfma_f32_16x16x32_bf16 v[108:111], a[156:159], v[228:231], v[108:111]
    s_waitcnt vmcnt(15)
    v_mfma_f32_16x16x32_bf16 v[72:75], a[80:83], v[168:171], v[72:75]
    buffer_load_dwordx4 v[40:43], v252, s[44:47], s25 offen offset:0 sc1
    s_waitcnt vmcnt(14)
    v_mfma_f32_16x16x32_bf16 v[72:75], a[100:103], v[172:175], v[72:75]
    s_waitcnt vmcnt(12)
    v_mfma_f32_16x16x32_bf16 v[72:75], a[120:123], v[176:179], v[72:75]
    s_waitcnt vmcnt(10)
    v_mfma_f32_16x16x32_bf16 v[72:75], a[140:143], v[180:183], v[72:75]
    v_mfma_f32_16x16x32_bf16 v[76:79], a[84:87], v[168:171], v[76:79]
    v_mfma_f32_16x16x32_bf16 v[76:79], a[104:107], v[172:175], v[76:79]
    buffer_load_dwordx4 v[44:47], v252, s[44:47], s25 offen offset:2048 sc1
    v_mfma_f32_16x16x32_bf16 v[76:79], a[124:127], v[176:179], v[76:79]
    v_mfma_f32_16x16x32_bf16 v[76:79], a[144:147], v[180:183], v[76:79]
    v_mfma_f32_16x16x32_bf16 v[80:83], a[88:91], v[168:171], v[80:83]
    v_mfma_f32_16x16x32_bf16 v[80:83], a[108:111], v[172:175], v[80:83]
    v_mfma_f32_16x16x32_bf16 v[80:83], a[128:131], v[176:179], v[80:83]
    buffer_load_dwordx4 v[48:51], v252, s[44:47], s28 offen offset:0 sc1
    v_mfma_f32_16x16x32_bf16 v[80:83], a[148:151], v[180:183], v[80:83]
    v_mfma_f32_16x16x32_bf16 v[84:87], a[92:95], v[168:171], v[84:87]
    v_mfma_f32_16x16x32_bf16 v[84:87], a[112:115], v[172:175], v[84:87]
    v_mfma_f32_16x16x32_bf16 v[84:87], a[132:135], v[176:179], v[84:87]
    v_mfma_f32_16x16x32_bf16 v[84:87], a[152:155], v[180:183], v[84:87]
    buffer_load_dwordx4 v[52:55], v252, s[44:47], s28 offen offset:2048 sc1
    v_mfma_f32_16x16x32_bf16 v[88:91], a[96:99], v[168:171], v[88:91]
    v_mfma_f32_16x16x32_bf16 v[88:91], a[116:119], v[172:175], v[88:91]
    v_mfma_f32_16x16x32_bf16 v[88:91], a[136:139], v[176:179], v[88:91]
    v_mfma_f32_16x16x32_bf16 v[88:91], a[156:159], v[180:183], v[88:91]
    s_waitcnt vmcnt(11)
    v_mfma_f32_16x16x32_bf16 v[132:135], a[160:163], v[8:11], v[132:135]
    buffer_load_dwordx4 v[56:59], v3, s[44:47], s25 offen offset:0 sc1
    s_waitcnt vmcnt(11)
    v_mfma_f32_16x16x32_bf16 v[132:135], a[180:183], v[12:15], v[132:135]
    s_waitcnt vmcnt(10)
    v_mfma_f32_16x16x32_bf16 v[132:135], a[200:203], v[16:19], v[132:135]
    s_waitcnt vmcnt(9)
    v_mfma_f32_16x16x32_bf16 v[132:135], a[220:223], v[20:23], v[132:135]
    v_mfma_f32_16x16x32_bf16 v[136:139], a[164:167], v[8:11], v[136:139]
    v_mfma_f32_16x16x32_bf16 v[136:139], a[184:187], v[12:15], v[136:139]
    buffer_load_dwordx4 v[60:63], v3, s[44:47], s25 offen offset:2048 sc1
    v_mfma_f32_16x16x32_bf16 v[136:139], a[204:207], v[16:19], v[136:139]
    v_mfma_f32_16x16x32_bf16 v[136:139], a[224:227], v[20:23], v[136:139]
    v_mfma_f32_16x16x32_bf16 v[140:143], a[168:171], v[8:11], v[140:143]
    v_mfma_f32_16x16x32_bf16 v[140:143], a[188:191], v[12:15], v[140:143]
    v_mfma_f32_16x16x32_bf16 v[140:143], a[208:211], v[16:19], v[140:143]
    buffer_load_dwordx4 v[64:67], v3, s[44:47], s28 offen offset:0 sc1
    v_mfma_f32_16x16x32_bf16 v[140:143], a[228:231], v[20:23], v[140:143]
    v_mfma_f32_16x16x32_bf16 v[144:147], a[172:175], v[8:11], v[144:147]
    ds_write_b128 v234, v[132:135] offset:0
    v_mfma_f32_16x16x32_bf16 v[144:147], a[192:195], v[12:15], v[144:147]
    v_mfma_f32_16x16x32_bf16 v[144:147], a[212:215], v[16:19], v[144:147]
    v_mfma_f32_16x16x32_bf16 v[144:147], a[232:235], v[20:23], v[144:147]
    buffer_load_dwordx4 v[68:71], v3, s[44:47], s28 offen offset:2048 sc1
    v_mfma_f32_16x16x32_bf16 v[148:151], a[176:179], v[8:11], v[148:151]
    ds_write_b128 v234, v[136:139] offset:1024
    v_mfma_f32_16x16x32_bf16 v[148:151], a[196:199], v[12:15], v[148:151]
    v_mfma_f32_16x16x32_bf16 v[148:151], a[216:219], v[16:19], v[148:151]
    v_mfma_f32_16x16x32_bf16 v[148:151], a[236:239], v[20:23], v[148:151]
    s_waitcnt vmcnt(11)
    v_mfma_f32_16x16x32_bf16 v[112:115], a[160:163], v[24:27], v[112:115]
    ds_write_b128 v234, v[140:143] offset:2048
    s_waitcnt vmcnt(10)
    v_mfma_f32_16x16x32_bf16 v[112:115], a[180:183], v[28:31], v[112:115]
    s_waitcnt vmcnt(9)
    v_mfma_f32_16x16x32_bf16 v[112:115], a[200:203], v[32:35], v[112:115]
    s_waitcnt vmcnt(8)
    v_mfma_f32_16x16x32_bf16 v[112:115], a[220:223], v[36:39], v[112:115]
    v_mfma_f32_16x16x32_bf16 v[116:119], a[164:167], v[24:27], v[116:119]
    ds_write_b128 v234, v[144:147] offset:3072
    v_mfma_f32_16x16x32_bf16 v[116:119], a[184:187], v[28:31], v[116:119]
    v_mfma_f32_16x16x32_bf16 v[116:119], a[204:207], v[32:35], v[116:119]
    v_mfma_f32_16x16x32_bf16 v[116:119], a[224:227], v[36:39], v[116:119]
    v_mfma_f32_16x16x32_bf16 v[120:123], a[168:171], v[24:27], v[120:123]
    ds_write_b128 v234, v[148:151] offset:4096
    v_mfma_f32_16x16x32_bf16 v[120:123], a[188:191], v[28:31], v[120:123]
    v_mfma_f32_16x16x32_bf16 v[120:123], a[208:211], v[32:35], v[120:123]
    v_mfma_f32_16x16x32_bf16 v[120:123], a[228:231], v[36:39], v[120:123]
    v_mfma_f32_16x16x32_bf16 v[124:127], a[172:175], v[24:27], v[124:127]
    ds_write_b128 v233, v[112:115] offset:0
    v_mfma_f32_16x16x32_bf16 v[124:127], a[192:195], v[28:31], v[124:127]
    v_mfma_f32_16x16x32_bf16 v[124:127], a[212:215], v[32:35], v[124:127]
    v_mfma_f32_16x16x32_bf16 v[124:127], a[232:235], v[36:39], v[124:127]
    v_mfma_f32_16x16x32_bf16 v[128:131], a[176:179], v[24:27], v[128:131]
    ds_write_b128 v233, v[116:119] offset:1024
    v_mfma_f32_16x16x32_bf16 v[128:131], a[196:199], v[28:31], v[128:131]
    v_mfma_f32_16x16x32_bf16 v[128:131], a[216:219], v[32:35], v[128:131]
    v_mfma_f32_16x16x32_bf16 v[128:131], a[236:239], v[36:39], v[128:131]
    s_waitcnt vmcnt(7)
    v_mfma_f32_16x16x32_bf16 v[92:95], a[160:163], v[40:43], v[92:95]
    ds_write_b128 v233, v[120:123] offset:2048
    s_waitcnt vmcnt(6)
    v_mfma_f32_16x16x32_bf16 v[92:95], a[180:183], v[44:47], v[92:95]
    s_waitcnt vmcnt(5)
    v_mfma_f32_16x16x32_bf16 v[92:95], a[200:203], v[48:51], v[92:95]
    s_waitcnt vmcnt(4)
    v_mfma_f32_16x16x32_bf16 v[92:95], a[220:223], v[52:55], v[92:95]
    v_mfma_f32_16x16x32_bf16 v[96:99], a[164:167], v[40:43], v[96:99]
    ds_write_b128 v233, v[124:127] offset:3072
    v_mfma_f32_16x16x32_bf16 v[96:99], a[184:187], v[44:47], v[96:99]
    v_mfma_f32_16x16x32_bf16 v[96:99], a[204:207], v[48:51], v[96:99]
    v_mfma_f32_16x16x32_bf16 v[96:99], a[224:227], v[52:55], v[96:99]
    v_mfma_f32_16x16x32_bf16 v[100:103], a[168:171], v[40:43], v[100:103]
    ds_write_b128 v233, v[128:131] offset:4096
    v_mfma_f32_16x16x32_bf16 v[100:103], a[188:191], v[44:47], v[100:103]
    v_mfma_f32_16x16x32_bf16 v[100:103], a[208:211], v[48:51], v[100:103]
    v_mfma_f32_16x16x32_bf16 v[100:103], a[228:231], v[52:55], v[100:103]
    v_mfma_f32_16x16x32_bf16 v[104:107], a[172:175], v[40:43], v[104:107]
    ds_write_b128 v232, v[92:95] offset:0
    s_waitcnt lgkmcnt(1)
    s_barrier
    v_mfma_f32_16x16x32_bf16 v[104:107], a[192:195], v[44:47], v[104:107]
    ds_read_b128 v[160:163], v7 offset:10240
    v_mfma_f32_16x16x32_bf16 v[104:107], a[212:215], v[48:51], v[104:107]
    ds_read_b128 v[156:159], v7 offset:5120
    v_mfma_f32_16x16x32_bf16 v[104:107], a[232:235], v[52:55], v[104:107]
    ds_read_b128 v[172:175], v7 offset:11264
    v_mfma_f32_16x16x32_bf16 v[108:111], a[176:179], v[40:43], v[108:111]
    ds_write_b128 v232, v[96:99] offset:1024
    ds_read_b128 v[168:171], v7 offset:6144
    v_mfma_f32_16x16x32_bf16 v[108:111], a[196:199], v[44:47], v[108:111]
    ds_read_b128 v[184:187], v7 offset:12288
    v_mfma_f32_16x16x32_bf16 v[108:111], a[216:219], v[48:51], v[108:111]
    ds_read_b128 v[180:183], v7 offset:7168
    v_mfma_f32_16x16x32_bf16 v[108:111], a[236:239], v[52:55], v[108:111]
    ds_read_b128 v[196:199], v7 offset:13312
    s_waitcnt vmcnt(3)
    v_mfma_f32_16x16x32_bf16 v[72:75], a[160:163], v[56:59], v[72:75]
    ds_write_b128 v232, v[100:103] offset:2048
    ds_read_b128 v[192:195], v7 offset:8192
    s_waitcnt vmcnt(2)
    v_mfma_f32_16x16x32_bf16 v[72:75], a[180:183], v[60:63], v[72:75]
    ds_read_b128 v[208:211], v7 offset:14336
    s_waitcnt vmcnt(1)
    v_mfma_f32_16x16x32_bf16 v[72:75], a[200:203], v[64:67], v[72:75]
    ds_read_b128 v[204:207], v7 offset:9216
    s_waitcnt vmcnt(0)
    v_mfma_f32_16x16x32_bf16 v[72:75], a[220:223], v[68:71], v[72:75]
    v_mfma_f32_16x16x32_bf16 v[76:79], a[164:167], v[56:59], v[76:79]
    ds_write_b128 v232, v[104:107] offset:3072
    s_waitcnt lgkmcnt(11)
    v_add_f32 v156, v156, v160
    v_add_f32_e64 v157, v157, v161
    v_mfma_f32_16x16x32_bf16 v[76:79], a[184:187], v[60:63], v[76:79]
    v_add_f32 v158, v158, v162
    v_add_f32 v159, v159, v163
    v_mfma_f32_16x16x32_bf16 v[76:79], a[204:207], v[64:67], v[76:79]
    s_waitcnt lgkmcnt(8)
    v_add_f32 v168, v168, v172
    v_add_f32_e64 v169, v169, v173
    v_mfma_f32_16x16x32_bf16 v[76:79], a[224:227], v[68:71], v[76:79]
    v_add_f32 v170, v170, v174
    v_add_f32 v171, v171, v175
    v_mfma_f32_16x16x32_bf16 v[80:83], a[168:171], v[56:59], v[80:83]
    ds_write_b128 v232, v[108:111] offset:4096
    s_waitcnt lgkmcnt(7)
    v_add_f32 v180, v180, v184
    v_add_f32_e64 v181, v181, v185
    v_mfma_f32_16x16x32_bf16 v[80:83], a[188:191], v[60:63], v[80:83]
    v_add_f32 v182, v182, v186
    v_add_f32 v183, v183, v187
    v_mfma_f32_16x16x32_bf16 v[80:83], a[208:211], v[64:67], v[80:83]
    s_waitcnt lgkmcnt(4)
    v_add_f32 v192, v192, v196
    v_add_f32_e64 v193, v193, v197
    v_mfma_f32_16x16x32_bf16 v[80:83], a[228:231], v[68:71], v[80:83]
    v_add_f32 v194, v194, v198
    v_add_f32 v195, v195, v199
    v_mfma_f32_16x16x32_bf16 v[84:87], a[172:175], v[56:59], v[84:87]
    s_waitcnt lgkmcnt(2)
    v_add_f32 v204, v204, v208
    v_add_f32_e64 v205, v205, v209
    s_waitcnt lgkmcnt(0)
    s_barrier
    ds_read_b128 v[152:155], v7 offset:0
    v_mfma_f32_16x16x32_bf16 v[84:87], a[192:195], v[60:63], v[84:87]
    v_add_f32 v206, v206, v210
    v_add_f32 v207, v207, v211
    ds_read_b128 v[164:167], v7 offset:1024
    v_mfma_f32_16x16x32_bf16 v[84:87], a[212:215], v[64:67], v[84:87]
    ds_read_b128 v[176:179], v7 offset:2048
    v_mfma_f32_16x16x32_bf16 v[84:87], a[232:235], v[68:71], v[84:87]
    ds_read_b128 v[188:191], v7 offset:3072
    v_mfma_f32_16x16x32_bf16 v[88:91], a[176:179], v[56:59], v[88:91]
    ds_read_b128 v[200:203], v7 offset:4096
    v_mfma_f32_16x16x32_bf16 v[88:91], a[196:199], v[60:63], v[88:91]
    v_mfma_f32_16x16x32_bf16 v[88:91], a[216:219], v[64:67], v[88:91]
    v_mfma_f32_16x16x32_bf16 v[88:91], a[236:239], v[68:71], v[88:91]
    v_pk_add_f32 v[72:73], v[72:73], v[156:157]
    v_pk_add_f32 v[74:75], v[74:75], v[158:159]
    v_pk_add_f32 v[76:77], v[76:77], v[168:169]
    v_pk_add_f32 v[78:79], v[78:79], v[170:171]
    v_pk_add_f32 v[80:81], v[80:81], v[180:181]
    v_pk_add_f32 v[82:83], v[82:83], v[182:183]
    v_pk_add_f32 v[84:85], v[84:85], v[192:193]
    v_pk_add_f32 v[86:87], v[86:87], v[194:195]
    v_pk_add_f32 v[88:89], v[88:89], v[204:205]
    v_pk_add_f32 v[90:91], v[90:91], v[206:207]
    s_waitcnt lgkmcnt(4)
    v_pk_add_f32 v[72:73], v[72:73], v[152:153]
    v_pk_add_f32 v[74:75], v[74:75], v[154:155]
    v_cvt_pk_bf16_f32 v8, v72, v73
    v_cvt_pk_bf16_f32 v9, v74, v75
    s_waitcnt lgkmcnt(3)
    v_pk_add_f32 v[76:77], v[76:77], v[164:165]
    v_pk_add_f32 v[78:79], v[78:79], v[166:167]
    v_cvt_pk_bf16_f32 v10, v76, v77
    v_cvt_pk_bf16_f32 v11, v78, v79
    ds_write_b128 v238, v[8:11] offset:0
    s_waitcnt lgkmcnt(3)
    v_pk_add_f32 v[80:81], v[80:81], v[176:177]
    v_pk_add_f32 v[82:83], v[82:83], v[178:179]
    v_cvt_pk_bf16_f32 v12, v80, v81
    v_cvt_pk_bf16_f32 v13, v82, v83
    s_waitcnt lgkmcnt(2)
    v_pk_add_f32 v[84:85], v[84:85], v[188:189]
    v_pk_add_f32 v[86:87], v[86:87], v[190:191]
    v_cvt_pk_bf16_f32 v14, v84, v85
    v_cvt_pk_bf16_f32 v15, v86, v87
    ds_write_b128 v238, v[12:15] offset:64
    s_nop 0
    s_waitcnt lgkmcnt(2)
    v_pk_add_f32 v[88:89], v[88:89], v[200:201]
    v_pk_add_f32 v[90:91], v[90:91], v[202:203]
    v_cvt_pk_bf16_f32 v16, v88, v89
    v_cvt_pk_bf16_f32 v17, v90, v91
    ds_write_b64 v239, v[16:17] offset:128
    ds_read_b128 v[20:23], v242 offset:0
    ds_read_b128 v[24:27], v242 offset:1056
    ds_read_b128 v[28:31], v242 offset:2112
    s_mov_b32 exec_hi, 0xfffffff
    s_waitcnt lgkmcnt(2)
    buffer_store_dwordx4 v[20:23], v4, s[36:39], 0 offen sc1
    s_waitcnt lgkmcnt(1)
    buffer_store_dwordx4 v[24:27], v4, s[36:39], s64 offen sc1
    s_mov_b32 exec_hi, 0xff
    s_waitcnt lgkmcnt(0)
    buffer_store_dwordx4 v[28:31], v4, s[36:39], s65 offen sc1
    s_mov_b32 exec_hi, -1
    s_cmp_lg_u32 s2, 0
    s_cbranch_scc1 .Lnz_31
    buffer_store_dword v236, off, s[40:43], 0 sc1
    buffer_store_dword v236, off, s[40:43], 0 offset:128 sc1
.Lnz_31:
.Lend:
    s_endpgm
.Lside:
    s_sub_u32 s52, s51, 20
    s_lshl3_add_u32 s52, s52, s50
    s_cmp_ge_u32 s52, 64
    s_cbranch_scc1 .Ls4
    v_lshrrev_b32 v3, 3, v1
    v_and_b32 v4, 7, v0
    s_lshr_b32 s60, s52, 3
    s_lshl_b32 s60, s60, 8
    s_and_b32 s61, s52, 3
    s_lshl2_add_u32 s60, s61, s60
    s_bfe_u32 s61, s52, 0x10002
    s_lshl1_add_u32 s60, s61, s60
    v_and_b32 v5, 0xf0, v1
    v_and_b32 v6, 1, v3
    v_add3_u32 v5, v5, v6, s60
    s_movk_i32 s61, 1280
    v_lshlrev_b32 v6, 4, v4
    v_mad_u32_u24 v5, v5, s61, v6
    s_waitcnt lgkmcnt(0)
    buffer_load_dwordx4 v[16:19], v5, s[20:23], 0 offen offset:0 nt
    buffer_load_dwordx4 v[20:23], v5, s[20:23], 0 offen offset:128 nt
    buffer_load_dwordx4 v[24:27], v5, s[20:23], 0 offen offset:256 nt
    buffer_load_dwordx4 v[28:31], v5, s[20:23], 0 offen offset:384 nt
    buffer_load_dwordx4 v[32:35], v5, s[20:23], 0 offen offset:512 nt
    buffer_load_dwordx4 v[36:39], v5, s[20:23], 0 offen offset:640 nt
    buffer_load_dwordx4 v[40:43], v5, s[20:23], 0 offen offset:768 nt
    buffer_load_dwordx4 v[44:47], v5, s[20:23], 0 offen offset:896 nt
    buffer_load_dwordx4 v[48:51], v5, s[20:23], 0 offen offset:1024 nt
    buffer_load_dwordx4 v[52:55], v5, s[20:23], 0 offen offset:1152 nt
    s_add_u32 s54, s52, 48
    s_sub_u32 s60, s54, 96
    s_cselect_b32 s54, s54, s60
    s_sub_u32 s75, s54, 48
    s_lshr_b32 s75, s75, 3
    s_mul_i32 s61, s50, 6
    s_add_u32 s75, s75, s61
    s_cmp_ge_u32 s75, 24
    s_cselect_b32 s62, s28, s24
    s_cselect_b32 s63, s29, s25
    s_cselect_b32 s61, 24, 0
    s_sub_u32 s61, s75, s61
    s_lshr_b32 s60, s54, 1
    s_cmp_ge_u32 s54, 48
    s_cselect_b32 s32, s62, s32
    s_cselect_b32 s33, s63, s33
    s_cselect_b32 s60, s61, s60
    s_sub_u32 s62, s60, 3
    s_cmp_lt_u32 s62, 2
    s_cselect_b32 s62, 7, 0
    s_xor_b32 s60, s60, s62
    s_sub_u32 s62, s60, 10
    s_cmp_lt_u32 s62, 2
    s_cselect_b32 s62, 1, 0
    s_xor_b32 s60, s60, s62
    s_and_b32 s62, s54, 1
    s_lshl1_add_u32 s62, s60, s62
    s_mul_i32 s62, s62, 40960
    s_lshl_b32 s60, s60, 7
    s_movk_i32 s61, 1280
    s_movk_i32 s53, 128
    s_cmp_ge_u32 s54, 48
    s_cselect_b32 s71, s60, s62
    s_cselect_b32 s61, 3072, s61
    s_cselect_b32 s53, 98304, s53
    v_and_b32 v230, 7, v0
    v_lshlrev_b32_e64 v230, 4, v230
    v_lshrrev_b32 v15, 3, v1
    v_mad_u32_u24 v230, v15, s61, v230
    s_cbranch_scc1 .Lj2_33
    buffer_load_dwordx4 v[136:139], v230, s[32:35], s71 offen offset:0 nt
    buffer_load_dwordx4 v[140:143], v230, s[32:35], s71 offen offset:128 nt
    buffer_load_dwordx4 v[144:147], v230, s[32:35], s71 offen offset:256 nt
    buffer_load_dwordx4 v[148:151], v230, s[32:35], s71 offen offset:384 nt
    buffer_load_dwordx4 v[152:155], v230, s[32:35], s71 offen offset:512 nt
    buffer_load_dwordx4 v[156:159], v230, s[32:35], s71 offen offset:640 nt
    buffer_load_dwordx4 v[160:163], v230, s[32:35], s71 offen offset:768 nt
    buffer_load_dwordx4 v[164:167], v230, s[32:35], s71 offen offset:896 nt
    buffer_load_dwordx4 v[168:171], v230, s[32:35], s71 offen offset:1024 nt
    buffer_load_dwordx4 v[172:175], v230, s[32:35], s71 offen offset:1152 nt
    s_branch .Lj2_32
.Lj2_33:
    buffer_load_dwordx4 v[136:139], v230, s[32:35], s71 offen
    s_add_u32 s71, s71, s53
    buffer_load_dwordx4 v[140:143], v230, s[32:35], s71 offen
    s_add_u32 s71, s71, s53
    buffer_load_dwordx4 v[144:147], v230, s[32:35], s71 offen
    s_add_u32 s71, s71, s53
    buffer_load_dwordx4 v[148:151], v230, s[32:35], s71 offen
    s_add_u32 s71, s71, s53
    buffer_load_dwordx4 v[152:155], v230, s[32:35], s71 offen
    s_add_u32 s71, s71, s53
    buffer_load_dwordx4 v[156:159], v230, s[32:35], s71 offen
    s_add_u32 s71, s71, s53
    buffer_load_dwordx4 v[160:163], v230, s[32:35], s71 offen
    s_add_u32 s71, s71, s53
    buffer_load_dwordx4 v[164:167], v230, s[32:35], s71 offen
    s_add_u32 s71, s71, s53
    buffer_load_dwordx4 v[168:171], v230, s[32:35], s71 offen
    s_add_u32 s71, s71, s53
    buffer_load_dwordx4 v[172:175], v230, s[32:35], s71 offen
    s_add_u32 s71, s71, s53
.Lj2_32:
    s_lshr_b32 s60, s50, 2
    s_lshl_b32 s60, s60, 5
    s_and_b32 s1, s50, 3
    s_add_u32 s1, s1, s60
    s_lshl_b32 s1, s1, 8
    s_lshr_b32 s55, s50, 2
    s_lshr_b32 s60, s51, 2
    s_lshl3_add_u32 s55, s55, s60
    s_and_b32 s59, s50, 3
    s_and_b32 s60, s51, 3
    s_lshl2_add_u32 s56, s59, s60
    s_and_b32 s60, s56, 1
    s_mul_i32 s57, s56, 6
    s_add_u32 s58, s57, 4
    s_lshl1_add_u32 s57, s60, s57
    s_lshl_b32 s61, s60, 2
    s_sub_u32 s58, s58, s61
    s_lshr_b32 s61, s57, 2
    s_sub_u32 s60, s61, 3
    s_cmp_lt_u32 s60, 2
    s_cselect_b32 s60, 7, 0
    s_xor_b32 s61, s61, s60
    s_sub_u32 s60, s61, 10
    s_cmp_lt_u32 s60, 2
    s_cselect_b32 s60, 1, 0
    s_xor_b32 s61, s61, s60
    s_lshl_b32 s61, s61, 7
    v_and_b32 v250, 7, v0
    v_lshl_add_u32 v253, v250, 4, s61
    s_lshr_b32 s60, s3, 1
    s_lshl_b32 s60, s60, 6
    s_mul_i32 s68, s59, 160
    s_add_u32 s68, s68, s60
    s_mul_i32 s60, s56, 81920
    s_add_u32 s60, s60, 393216
    v_lshl_add_u32 v252, v0, 4, s60
    s_mul_i32 s69, s59, 10
    s_add_u32 s69, s69, s3
    s_lshl_b32 s69, s69, 10
    v_mov_b32 v248, 1
    s_and_b32 s60, s55, 7
    s_lshr_b32 s61, s3, 1
    s_lshl1_add_u32 s60, s60, s61
    s_lshr_b32 s61, s55, 3
    s_lshl1_add_u32 s60, s60, s61
    s_and_b32 s61, s3, 1
    s_lshl1_add_u32 s60, s60, s61
    s_lshl_b32 s60, s60, 12
    v_and_b32_e64 v250, 31, v0
    v_lshl_add_u32 v251, v250, 3, s60
    v_lshrrev_b32_e64 v250, 5, v0
    v_lshl_add_u32 v251, v250, 11, v251
    s_movk_i32 s61, 528
    v_lshlrev_b32 v5, 3, v3
    v_mad_u32_u24 v5, v4, s61, v5
    v_and_b32 v6, 31, v0
    v_lshlrev_b32 v6, 4, v6
    v_lshrrev_b32_e64 v8, 5, v1
    v_mad_u32_u24 v6, v8, s61, v6
    s_lshl_b32 s60, s52, 8
    v_and_b32 v7, 15, v0
    s_and_b32 s61, s60, 0x2000
    s_add_u32 s61, s61, s60
    v_lshl_add_u32 v7, v7, 4, s61
    v_lshrrev_b32 v8, 4, v1
    s_mov_b32 s61, 32768
    v_mad_u32_u24 v7, v8, s61, v7
    s_waitcnt vmcnt(19)
    ds_write_b64 v5, v[16:17] offset:0
    ds_write_b64 v5, v[18:19] offset:256
    s_waitcnt vmcnt(18)
    ds_write_b64 v5, v[20:21] offset:4224
    ds_write_b64 v5, v[22:23] offset:4480
    s_waitcnt vmcnt(17)
    ds_write_b64 v5, v[24:25] offset:8448
    ds_write_b64 v5, v[26:27] offset:8704
    s_waitcnt vmcnt(16)
    ds_write_b64 v5, v[28:29] offset:12672
    ds_write_b64 v5, v[30:31] offset:12928
    s_waitcnt vmcnt(15)
    ds_write_b64 v5, v[32:33] offset:16896
    ds_write_b64 v5, v[34:35] offset:17152
    s_waitcnt vmcnt(14)
    ds_write_b64 v5, v[36:37] offset:21120
    ds_write_b64 v5, v[38:39] offset:21376
    s_waitcnt vmcnt(13)
    ds_write_b64 v5, v[40:41] offset:25344
    ds_write_b64 v5, v[42:43] offset:25600
    s_waitcnt vmcnt(12)
    ds_write_b64 v5, v[44:45] offset:29568
    ds_write_b64 v5, v[46:47] offset:29824
    s_waitcnt vmcnt(11)
    ds_write_b64 v5, v[48:49] offset:33792
    ds_write_b64 v5, v[50:51] offset:34048
    s_waitcnt vmcnt(10)
    ds_write_b64 v5, v[52:53] offset:38016
    ds_write_b64 v5, v[54:55] offset:38272
    s_load_dword s73, s[40:41], 0x80
    s_load_dword s74, s[40:41], 0x0
    s_waitcnt lgkmcnt(0)
    s_barrier
    ds_read_b128 v[96:99], v6 offset:0
    ds_read_b128 v[100:103], v6 offset:4224
    ds_read_b128 v[104:107], v6 offset:8448
    ds_read_b128 v[108:111], v6 offset:12672
    ds_read_b128 v[112:115], v6 offset:16896
    ds_read_b128 v[116:119], v6 offset:21120
    ds_read_b128 v[120:123], v6 offset:25344
    ds_read_b128 v[124:127], v6 offset:29568
    ds_read_b128 v[128:131], v6 offset:33792
    ds_read_b128 v[132:135], v6 offset:38016
    s_mov_b32 s67, s73
    s_cmp_lt_u32 s67, 1
    s_cbranch_scc1 .Lslow_34
.Lback_35:
    s_and_b32 s0, s67, 2
    s_lshl_b32 s0, s0, 20
    s_add_u32 s44, s44, s0
    s_addc_u32 s45, s45, 0
    s_mov_b32 s67, s74
    s_cmp_lt_u32 s67, 1
    s_cbranch_scc1 .Lslow_36
.Lback_37:
    s_mov_b32 s72, 0x3f803f80
    v_mov_b32 v8, 0
    v_mov_b32 v9, 0
    v_mov_b32 v10, 0
    v_mov_b32 v11, 0
    s_mov_b32 s61, 12582912
    s_waitcnt lgkmcnt(9)
    buffer_store_dwordx4 v[96:99], v7, s[44:47], s61 offen sc1
    v_dot2c_f32_bf16 v8, s72, v16
    v_dot2c_f32_bf16 v10, v16, v16
    v_dot2c_f32_bf16 v9, s72, v17
    v_dot2c_f32_bf16 v11, v17, v17
    v_dot2c_f32_bf16 v8, s72, v18
    v_dot2c_f32_bf16 v10, v18, v18
    v_dot2c_f32_bf16 v9, s72, v19
    v_dot2c_f32_bf16 v11, v19, v19
    s_mov_b32 s61, 13107200
    s_waitcnt lgkmcnt(8)
    buffer_store_dwordx4 v[100:103], v7, s[44:47], s61 offen sc1
    v_dot2c_f32_bf16 v8, s72, v20
    v_dot2c_f32_bf16 v10, v20, v20
    v_dot2c_f32_bf16 v9, s72, v21
    v_dot2c_f32_bf16 v11, v21, v21
    v_dot2c_f32_bf16 v8, s72, v22
    v_dot2c_f32_bf16 v10, v22, v22
    v_dot2c_f32_bf16 v9, s72, v23
    v_dot2c_f32_bf16 v11, v23, v23
    s_mov_b32 s61, 13631488
    s_waitcnt lgkmcnt(7)
    buffer_store_dwordx4 v[104:107], v7, s[44:47], s61 offen sc1
    v_dot2c_f32_bf16 v8, s72, v24
    v_dot2c_f32_bf16 v10, v24, v24
    v_dot2c_f32_bf16 v9, s72, v25
    v_dot2c_f32_bf16 v11, v25, v25
    v_dot2c_f32_bf16 v8, s72, v26
    v_dot2c_f32_bf16 v10, v26, v26
    v_dot2c_f32_bf16 v9, s72, v27
    v_dot2c_f32_bf16 v11, v27, v27
    s_mov_b32 s61, 14155776
    s_waitcnt lgkmcnt(6)
    buffer_store_dwordx4 v[108:111], v7, s[44:47], s61 offen sc1
    v_dot2c_f32_bf16 v8, s72, v28
    v_dot2c_f32_bf16 v10, v28, v28
    v_dot2c_f32_bf16 v9, s72, v29
    v_dot2c_f32_bf16 v11, v29, v29
    v_dot2c_f32_bf16 v8, s72, v30
    v_dot2c_f32_bf16 v10, v30, v30
    v_dot2c_f32_bf16 v9, s72, v31
    v_dot2c_f32_bf16 v11, v31, v31
    s_mov_b32 s61, 12591104
    s_waitcnt lgkmcnt(5)
    buffer_store_dwordx4 v[112:115], v7, s[44:47], s61 offen sc1
    v_dot2c_f32_bf16 v8, s72, v32
    v_dot2c_f32_bf16 v10, v32, v32
    v_dot2c_f32_bf16 v9, s72, v33
    v_dot2c_f32_bf16 v11, v33, v33
    v_dot2c_f32_bf16 v8, s72, v34
    v_dot2c_f32_bf16 v10, v34, v34
    v_dot2c_f32_bf16 v9, s72, v35
    v_dot2c_f32_bf16 v11, v35, v35
    s_mov_b32 s61, 13115392
    s_waitcnt lgkmcnt(4)
    buffer_store_dwordx4 v[116:119], v7, s[44:47], s61 offen sc1
    v_dot2c_f32_bf16 v8, s72, v36
    v_dot2c_f32_bf16 v10, v36, v36
    v_dot2c_f32_bf16 v9, s72, v37
    v_dot2c_f32_bf16 v11, v37, v37
    v_dot2c_f32_bf16 v8, s72, v38
    v_dot2c_f32_bf16 v10, v38, v38
    v_dot2c_f32_bf16 v9, s72, v39
    v_dot2c_f32_bf16 v11, v39, v39
    s_mov_b32 s61, 13639680
    s_waitcnt lgkmcnt(3)
    buffer_store_dwordx4 v[120:123], v7, s[44:47], s61 offen sc1
    v_dot2c_f32_bf16 v8, s72, v40
    v_dot2c_f32_bf16 v10, v40, v40
    v_dot2c_f32_bf16 v9, s72, v41
    v_dot2c_f32_bf16 v11, v41, v41
    v_dot2c_f32_bf16 v8, s72, v42
    v_dot2c_f32_bf16 v10, v42, v42
    v_dot2c_f32_bf16 v9, s72, v43
    v_dot2c_f32_bf16 v11, v43, v43
    s_mov_b32 s61, 14163968
    s_waitcnt lgkmcnt(2)
    buffer_store_dwordx4 v[124:127], v7, s[44:47], s61 offen sc1
    v_dot2c_f32_bf16 v8, s72, v44
    v_dot2c_f32_bf16 v10, v44, v44
    v_dot2c_f32_bf16 v9, s72, v45
    v_dot2c_f32_bf16 v11, v45, v45
    v_dot2c_f32_bf16 v8, s72, v46
    v_dot2c_f32_bf16 v10, v46, v46
    v_dot2c_f32_bf16 v9, s72, v47
    v_dot2c_f32_bf16 v11, v47, v47
    s_mov_b32 s61, 8912896
    s_waitcnt lgkmcnt(1)
    buffer_store_dwordx4 v[128:131], v7, s[44:47], s61 offen sc1
    v_dot2c_f32_bf16 v8, s72, v48
    v_dot2c_f32_bf16 v10, v48, v48
    v_dot2c_f32_bf16 v9, s72, v49
    v_dot2c_f32_bf16 v11, v49, v49
    v_dot2c_f32_bf16 v8, s72, v50
    v_dot2c_f32_bf16 v10, v50, v50
    v_dot2c_f32_bf16 v9, s72, v51
    v_dot2c_f32_bf16 v11, v51, v51
    s_mov_b32 s61, 8921088
    s_waitcnt lgkmcnt(0)
    buffer_store_dwordx4 v[132:135], v7, s[44:47], s61 offen sc1
    v_dot2c_f32_bf16 v8, s72, v52
    v_dot2c_f32_bf16 v10, v52, v52
    v_dot2c_f32_bf16 v9, s72, v53
    v_dot2c_f32_bf16 v11, v53, v53
    v_dot2c_f32_bf16 v8, s72, v54
    v_dot2c_f32_bf16 v10, v54, v54
    v_dot2c_f32_bf16 v9, s72, v55
    v_dot2c_f32_bf16 v11, v55, v55
    s_nop 1
    v_add_f32 v8, v8, v9
    v_add_f32 v10, v10, v11
    s_nop 0
    v_add_f32_dpp v8, v8, v8 quad_perm:[1,0,3,2] row_mask:0xf bank_mask:0xf
    v_add_f32_dpp v10, v10, v10 quad_perm:[1,0,3,2] row_mask:0xf bank_mask:0xf
    s_nop 0
    v_add_f32_dpp v8, v8, v8 quad_perm:[2,3,0,1] row_mask:0xf bank_mask:0xf
    v_add_f32_dpp v10, v10, v10 quad_perm:[2,3,0,1] row_mask:0xf bank_mask:0xf
    s_nop 0
    v_add_f32_dpp v8, v8, v8 row_half_mirror row_mask:0xf bank_mask:0xf
    v_add_f32_dpp v10, v10, v10 row_half_mirror row_mask:0xf bank_mask:0xf
    v_mul_f32 v8, 0x3acccccd, v8
    v_mul_f32 v10, 0x3acccccd, v10
    v_fma_f32 v10, -v8, v8, v10
    v_max_f32_e64 v10, 0, v10
    v_cvt_pk_bf16_f32 v8, v8, v10
    v_and_b32 v10, 0xffff0000, v8
    v_lshlrev_b32_e64 v8, 16, v8
    v_add_f32 v10, 0x3727c5ac, v10
    v_cvt_pk_bf16_f32 v10, 0, v10
    v_sqrt_f32 v10, v10
    s_nop 0
    v_cvt_pk_bf16_f32 v10, 0, v10
    v_rcp_f32 v10, v10
    v_lshlrev_b32 v12, 5, v0
    v_mul_f32 v11, -v8, v10
    s_lshl_b32 s61, s3, 6
    s_add_u32 s61, s61, s60
    s_add_u32 s61, s61, 49152
    ds_bpermute_b32 v8, v12, v10
    ds_bpermute_b32 v9, v12, v11
    v_lshlrev_b32 v12, 3, v0
    s_waitcnt lgkmcnt(0)
    s_mov_b64 exec, 0xff
    buffer_store_dwordx2 v[8:9], v12, s[44:47], s61 offen sc1
    s_mov_b64 exec, -1
    s_branch .Lr1
.Ls4:
    s_sub_u32 s64, s52, 64
    s_lshr_b32 s64, s64, 3
    s_and_b32 s65, s50, 3
    s_lshr_b32 s60, s50, 2
    s_lshl1_add_u32 s65, s65, s60
    s_mul_i32 s60, s64, 160
    s_lshl3_add_u32 s60, s3, s60
    s_mul_i32 s60, s60, 3072
    s_mul_i32 s61, s65, 3
    s_add_u32 s61, s61, 1
    s_sub_u32 s62, s61, 3
    s_cmp_lt_u32 s62, 2
    s_cselect_b32 s62, 7, 0
    s_xor_b32 s61, s61, s62
    s_sub_u32 s62, s61, 10
    s_cmp_lt_u32 s62, 2
    s_cselect_b32 s62, 1, 0
    s_xor_b32 s61, s61, s62
    s_lshl_b32 s61, s61, 7
    s_add_u32 s60, s60, s61
    v_lshrrev_b32_e64 v3, 3, v0
    v_and_b32 v4, 7, v0
    v_lshl_add_u32 v2, v4, 4, s60
    s_movk_i32 s61, 3072
    v_mad_u32_u24 v2, v3, s61, v2
    s_mov_b32 s60, 0
    s_waitcnt lgkmcnt(0)
    buffer_load_dwordx4 v[16:19], v2, s[24:27], s60 offen
    buffer_load_dwordx4 v[20:23], v2, s[28:31], s60 offen
    s_add_u32 s60, s60, 98304
    buffer_load_dwordx4 v[24:27], v2, s[24:27], s60 offen
    buffer_load_dwordx4 v[28:31], v2, s[28:31], s60 offen
    s_add_u32 s60, s60, 98304
    buffer_load_dwordx4 v[32:35], v2, s[24:27], s60 offen
    buffer_load_dwordx4 v[36:39], v2, s[28:31], s60 offen
    s_add_u32 s60, s60, 98304
    buffer_load_dwordx4 v[40:43], v2, s[24:27], s60 offen
    buffer_load_dwordx4 v[44:47], v2, s[28:31], s60 offen
    s_add_u32 s60, s60, 98304
    buffer_load_dwordx4 v[48:51], v2, s[24:27], s60 offen
    buffer_load_dwordx4 v[52:55], v2, s[28:31], s60 offen
    s_add_u32 s60, s60, 98304
    s_add_u32 s54, s52, 48
    s_sub_u32 s60, s54, 96
    s_cselect_b32 s54, s54, s60
    s_sub_u32 s75, s54, 48
    s_lshr_b32 s75, s75, 3
    s_mul_i32 s61, s50, 6
    s_add_u32 s75, s75, s61
    s_cmp_ge_u32 s75, 24
    s_cselect_b32 s62, s28, s24
    s_cselect_b32 s63, s29, s25
    s_cselect_b32 s61, 24, 0
    s_sub_u32 s61, s75, s61
    s_lshr_b32 s60, s54, 1
    s_cmp_ge_u32 s54, 48
    s_cselect_b32 s32, s62, s32
    s_cselect_b32 s33, s63, s33
    s_cselect_b32 s60, s61, s60
    s_sub_u32 s62, s60, 3
    s_cmp_lt_u32 s62, 2
    s_cselect_b32 s62, 7, 0
    s_xor_b32 s60, s60, s62
    s_sub_u32 s62, s60, 10
    s_cmp_lt_u32 s62, 2
    s_cselect_b32 s62, 1, 0
    s_xor_b32 s60, s60, s62
    s_and_b32 s62, s54, 1
    s_lshl1_add_u32 s62, s60, s62
    s_mul_i32 s62, s62, 40960
    s_lshl_b32 s60, s60, 7
    s_movk_i32 s61, 1280
    s_movk_i32 s53, 128
    s_cmp_ge_u32 s54, 48
    s_cselect_b32 s71, s60, s62
    s_cselect_b32 s61, 3072, s61
    s_cselect_b32 s53, 98304, s53
    v_and_b32 v230, 7, v0
    v_lshlrev_b32_e64 v230, 4, v230
    v_lshrrev_b32 v15, 3, v1
    v_mad_u32_u24 v230, v15, s61, v230
    s_cbranch_scc1 .Lj2_39
    buffer_load_dwordx4 v[136:139], v230, s[32:35], s71 offen offset:0 nt
    buffer_load_dwordx4 v[140:143], v230, s[32:35], s71 offen offset:128 nt
    buffer_load_dwordx4 v[144:147], v230, s[32:35], s71 offen offset:256 nt
    buffer_load_dwordx4 v[148:151], v230, s[32:35], s71 offen offset:384 nt
    buffer_load_dwordx4 v[152:155], v230, s[32:35], s71 offen offset:512 nt
    buffer_load_dwordx4 v[156:159], v230, s[32:35], s71 offen offset:640 nt
    buffer_load_dwordx4 v[160:163], v230, s[32:35], s71 offen offset:768 nt
    buffer_load_dwordx4 v[164:167], v230, s[32:35], s71 offen offset:896 nt
    buffer_load_dwordx4 v[168:171], v230, s[32:35], s71 offen offset:1024 nt
    buffer_load_dwordx4 v[172:175], v230, s[32:35], s71 offen offset:1152 nt
    s_branch .Lj2_38
.Lj2_39:
    buffer_load_dwordx4 v[136:139], v230, s[32:35], s71 offen
    s_add_u32 s71, s71, s53
    buffer_load_dwordx4 v[140:143], v230, s[32:35], s71 offen
    s_add_u32 s71, s71, s53
    buffer_load_dwordx4 v[144:147], v230, s[32:35], s71 offen
    s_add_u32 s71, s71, s53
    buffer_load_dwordx4 v[148:151], v230, s[32:35], s71 offen
    s_add_u32 s71, s71, s53
    buffer_load_dwordx4 v[152:155], v230, s[32:35], s71 offen
    s_add_u32 s71, s71, s53
    buffer_load_dwordx4 v[156:159], v230, s[32:35], s71 offen
    s_add_u32 s71, s71, s53
    buffer_load_dwordx4 v[160:163], v230, s[32:35], s71 offen
    s_add_u32 s71, s71, s53
    buffer_load_dwordx4 v[164:167], v230, s[32:35], s71 offen
    s_add_u32 s71, s71, s53
    buffer_load_dwordx4 v[168:171], v230, s[32:35], s71 offen
    s_add_u32 s71, s71, s53
    buffer_load_dwordx4 v[172:175], v230, s[32:35], s71 offen
    s_add_u32 s71, s71, s53
.Lj2_38:
    s_lshr_b32 s60, s50, 2
    s_lshl_b32 s60, s60, 5
    s_and_b32 s1, s50, 3
    s_add_u32 s1, s1, s60
    s_lshl_b32 s1, s1, 8
    s_lshr_b32 s55, s50, 2
    s_lshr_b32 s60, s51, 2
    s_lshl3_add_u32 s55, s55, s60
    s_and_b32 s59, s50, 3
    s_and_b32 s60, s51, 3
    s_lshl2_add_u32 s56, s59, s60
    s_and_b32 s60, s56, 1
    s_mul_i32 s57, s56, 6
    s_add_u32 s58, s57, 4
    s_lshl1_add_u32 s57, s60, s57
    s_lshl_b32 s61, s60, 2
    s_sub_u32 s58, s58, s61
    s_lshr_b32 s61, s57, 2
    s_sub_u32 s60, s61, 3
    s_cmp_lt_u32 s60, 2
    s_cselect_b32 s60, 7, 0
    s_xor_b32 s61, s61, s60
    s_sub_u32 s60, s61, 10
    s_cmp_lt_u32 s60, 2
    s_cselect_b32 s60, 1, 0
    s_xor_b32 s61, s61, s60
    s_lshl_b32 s61, s61, 7
    v_and_b32 v250, 7, v0
    v_lshl_add_u32 v253, v250, 4, s61
    s_lshr_b32 s60, s3, 1
    s_lshl_b32 s60, s60, 6
    s_mul_i32 s68, s59, 160
    s_add_u32 s68, s68, s60
    s_mul_i32 s60, s56, 81920
    s_add_u32 s60, s60, 393216
    v_lshl_add_u32 v252, v0, 4, s60
    s_mul_i32 s69, s59, 10
    s_add_u32 s69, s69, s3
    s_lshl_b32 s69, s69, 10
    v_mov_b32 v248, 1
    s_and_b32 s60, s55, 7
    s_lshr_b32 s61, s3, 1
    s_lshl1_add_u32 s60, s60, s61
    s_lshr_b32 s61, s55, 3
    s_lshl1_add_u32 s60, s60, s61
    s_and_b32 s61, s3, 1
    s_lshl1_add_u32 s60, s60, s61
    s_lshl_b32 s60, s60, 12
    v_and_b32_e64 v250, 31, v0
    v_lshl_add_u32 v251, v250, 3, s60
    v_lshrrev_b32 v250, 5, v0
    v_lshl_add_u32 v251, v250, 11, v251
    s_lshl_b32 s60, s3, 9
    v_lshl_add_u32 v5, v3, 6, s60
    v_and_b32_e64 v6, 1, v0
    v_lshl_add_u32 v5, v6, 4, v5
    v_bfe_u32 v6, v0, 1, 2
    v_lshlrev_b32_e64 v7, 5, v6
    v_xor_b32 v5, v5, v7
    s_movk_i32 s60, 10240
    v_mad_u32_u24 v5, v6, s60, v5
    v_xor_b32 v6, 32, v5
    v_lshrrev_b32 v7, 5, v0
    v_bfe_u32 v8, v0, 2, 2
    v_lshl_add_u32 v7, v7, 3, v8
    v_lshlrev_b32 v7, 6, v7
    v_and_b32 v8, 3, v0
    v_lshl_add_u32 v7, v8, 4, v7
    v_bfe_u32 v8, v0, 4, 1
    v_lshl_add_u32 v7, v8, 3, v7
    s_lshl_b32 s61, s3, 5
    v_xor_b32 v7, s61, v7
    s_mul_i32 s61, s3, 10240
    v_add_u32_e64 v7, s61, v7
    s_waitcnt vmcnt(19)
    ds_write_b128 v5, v[16:19] offset:0
    s_waitcnt vmcnt(18)
    ds_write_b128 v6, v[20:23] offset:0
    s_waitcnt vmcnt(17)
    ds_write_b128 v5, v[24:27] offset:2048
    s_waitcnt vmcnt(16)
    ds_write_b128 v6, v[28:31] offset:2048
    s_waitcnt vmcnt(15)
    ds_write_b128 v5, v[32:35] offset:4096
    s_waitcnt vmcnt(14)
    ds_write_b128 v6, v[36:39] offset:4096
    s_waitcnt vmcnt(13)
    ds_write_b128 v5, v[40:43] offset:6144
    s_waitcnt vmcnt(12)
    ds_write_b128 v6, v[44:47] offset:6144
    s_waitcnt vmcnt(11)
    ds_write_b128 v5, v[48:51] offset:8192
    s_waitcnt vmcnt(10)
    ds_write_b128 v6, v[52:55] offset:8192
    s_load_dword s73, s[40:41], 0x80
    s_load_dword s74, s[40:41], 0x0
    s_waitcnt lgkmcnt(0)
    s_barrier
    ds_read_b64_tr_b16 v[96:97], v7 offset:0
    ds_read_b64_tr_b16 v[98:99], v7 offset:256
    ds_read_b64_tr_b16 v[100:101], v7 offset:1024
    ds_read_b64_tr_b16 v[102:103], v7 offset:1280
    ds_read_b64_tr_b16 v[104:105], v7 offset:2048
    ds_read_b64_tr_b16 v[106:107], v7 offset:2304
    ds_read_b64_tr_b16 v[108:109], v7 offset:3072
    ds_read_b64_tr_b16 v[110:111], v7 offset:3328
    ds_read_b64_tr_b16 v[112:113], v7 offset:4096
    ds_read_b64_tr_b16 v[114:115], v7 offset:4352
    ds_read_b64_tr_b16 v[116:117], v7 offset:5120
    ds_read_b64_tr_b16 v[118:119], v7 offset:5376
    ds_read_b64_tr_b16 v[120:121], v7 offset:6144
    ds_read_b64_tr_b16 v[122:123], v7 offset:6400
    ds_read_b64_tr_b16 v[124:125], v7 offset:7168
    ds_read_b64_tr_b16 v[126:127], v7 offset:7424
    ds_read_b64_tr_b16 v[128:129], v7 offset:8192
    ds_read_b64_tr_b16 v[130:131], v7 offset:8448
    ds_read_b64_tr_b16 v[132:133], v7 offset:9216
    ds_read_b64_tr_b16 v[134:135], v7 offset:9472
    s_lshl2_add_u32 s60, s65, s3
    s_lshl2_add_u32 s60, s60, s64
    s_mul_i32 s60, s60, 10240
    s_add_u32 s60, s60, 393216
    v_lshlrev_b32 v9, 4, v0
    s_mov_b32 s67, s73
    s_cmp_lt_u32 s67, 1
    s_cbranch_scc1 .Lslow_40
.Lback_41:
    s_and_b32 s0, s67, 2
    s_lshl_b32 s0, s0, 20
    s_add_u32 s44, s44, s0
    s_addc_u32 s45, s45, 0
    s_mov_b32 s67, s74
    s_cmp_lt_u32 s67, 1
    s_cbranch_scc1 .Lslow_42
.Lback_43:
    s_waitcnt lgkmcnt(15)
    buffer_store_dwordx4 v[96:99], v9, s[44:47], s60 offen offset:0 sc1
    buffer_store_dwordx4 v[100:103], v9, s[44:47], s60 offen offset:1024 sc1
    s_waitcnt lgkmcnt(14)
    buffer_store_dwordx4 v[104:107], v9, s[44:47], s60 offen offset:2048 sc1
    s_waitcnt lgkmcnt(12)
    buffer_store_dwordx4 v[108:111], v9, s[44:47], s60 offen offset:3072 sc1
    s_add_u32 s60, s60, 4096
    s_waitcnt lgkmcnt(10)
    buffer_store_dwordx4 v[112:115], v9, s[44:47], s60 offen offset:0 sc1
    s_waitcnt lgkmcnt(8)
    buffer_store_dwordx4 v[116:119], v9, s[44:47], s60 offen offset:1024 sc1
    s_waitcnt lgkmcnt(6)
    buffer_store_dwordx4 v[120:123], v9, s[44:47], s60 offen offset:2048 sc1
    s_waitcnt lgkmcnt(4)
    buffer_store_dwordx4 v[124:127], v9, s[44:47], s60 offen offset:3072 sc1
    s_add_u32 s60, s60, 4096
    s_waitcnt lgkmcnt(2)
    buffer_store_dwordx4 v[128:131], v9, s[44:47], s60 offen offset:0 sc1
    s_waitcnt lgkmcnt(0)
    buffer_store_dwordx4 v[132:135], v9, s[44:47], s60 offen offset:1024 sc1
.Lr1:
    s_mov_b32 s52, s54
    s_mov_b32 s19, s54
    s_bitcmp1_b32 s3, 0
    s_cselect_b32 s24, s28, s24
    s_cselect_b32 s25, s29, s25
    s_movk_i32 s12, 6144
    s_movk_i32 s13, 12288
    s_movk_i32 s14, 18432
    s_movk_i32 s15, 3072
    s_cmp_ge_u32 s52, 48
    s_cbranch_scc1 .Ls2
    v_and_b32 v250, 56, v0
    v_add_u32_e64 v250, s68, v250
    v_subrev_u32 v249, 640, v250
    v_min_u32_e64 v250, v250, v249
    v_mad_u32_u24 v254, v250, s15, v253
    s_add_u32 s68, s68, 128
    buffer_load_dwordx4 v[8:11], v254, s[24:27], 0 offen offset:0
    buffer_load_dwordx4 v[12:15], v254, s[24:27], 0 offen offset:3072
    buffer_load_dwordx4 v[16:19], v254, s[24:27], s12 offen offset:0
    buffer_load_dwordx4 v[20:23], v254, s[24:27], s12 offen offset:3072
    buffer_load_dwordx4 v[24:27], v254, s[24:27], s13 offen offset:0
    buffer_load_dwordx4 v[28:31], v254, s[24:27], s13 offen offset:3072
    buffer_load_dwordx4 v[32:35], v254, s[24:27], s14 offen offset:0
    buffer_load_dwordx4 v[36:39], v254, s[24:27], s14 offen offset:3072
    v_and_b32 v250, 56, v0
    v_add_u32 v250, s68, v250
    v_subrev_u32 v249, 640, v250
    v_min_u32_e64 v250, v250, v249
    v_mad_u32_u24 v254, v250, s15, v253
    s_add_u32 s68, s68, 128
    buffer_load_dwordx4 v[40:43], v254, s[24:27], 0 offen offset:0
    buffer_load_dwordx4 v[44:47], v254, s[24:27], 0 offen offset:3072
    v_lshrrev_b32 v3, 3, v1
    v_and_b32 v4, 7, v0
    s_movk_i32 s61, 1344
    v_lshlrev_b32 v5, 4, v4
    v_mad_u32_u24 v5, v3, s61, v5
    v_lshrrev_b32_e64 v216, 4, v0
    v_bfe_u32 v217, v0, 2, 2
    v_lshl_add_u32 v216, v216, 3, v217
    s_mul_i32 s60, s3, 320
    v_mov_b32_e64 v217, s60
    v_mad_u32_u24 v216, v216, s61, v217
    v_and_b32 v217, 3, v0
    v_lshl_add_u32 v218, v217, 3, v216
    v_lshl_add_u32 v216, v217, 4, v216
    s_waitcnt vmcnt(10)
    s_barrier
    s_mov_b32 s23, 1
    s_cmp_lg_u32 s3, 0
    s_cbranch_scc1 .Lnoarr_44
    s_atomic_add s23, s[44:45], s1 offset:2048 glc
.Lnoarr_44:
    ds_write_b128 v5, v[136:139] offset:49152
    buffer_load_dwordx4 v[48:51], v254, s[24:27], s12 offen offset:0
    ds_write_b128 v5, v[140:143] offset:49280
    buffer_load_dwordx4 v[52:55], v254, s[24:27], s12 offen offset:3072
    ds_write_b128 v5, v[144:147] offset:49408
    buffer_load_dwordx4 v[56:59], v254, s[24:27], s13 offen offset:0
    ds_write_b128 v5, v[148:151] offset:49536
    buffer_load_dwordx4 v[60:63], v254, s[24:27], s13 offen offset:3072
    ds_write_b128 v5, v[152:155] offset:49664
    ds_write_b128 v5, v[156:159] offset:49792
    ds_write_b128 v5, v[160:163] offset:49920
    ds_write_b128 v5, v[164:167] offset:50048
    ds_write_b128 v5, v[168:171] offset:50176
    ds_write_b128 v5, v[172:175] offset:50304
    s_waitcnt lgkmcnt(0)
    s_cmp_lg_u32 s23, 11
    s_cbranch_scc1 .Lnotlast_45
    s_mov_b32 exec_lo, 15
    s_mov_b32 exec_hi, 15
    v_lshlrev_b32 v217, 8, v0
    s_mov_b32 s67, 4096
    buffer_atomic_add v248, v217, s[44:47], s67 offen sc1
    s_mov_b64 exec, -1
.Lnotlast_45:
    buffer_load_dwordx4 v[64:67], v254, s[24:27], s14 offen offset:0
    buffer_load_dwordx4 v[68:71], v254, s[24:27], s14 offen offset:3072
    v_and_b32 v250, 56, v0
    v_add_u32_e64 v250, s68, v250
    v_subrev_u32 v249, 640, v250
    v_min_u32_e64 v250, v250, v249
    v_mad_u32_u24 v254, v250, s15, v253
    s_add_u32 s68, s68, 128
    buffer_load_dwordx4 v[72:75], v254, s[24:27], 0 offen offset:0
    buffer_load_dwordx4 v[76:79], v254, s[24:27], 0 offen offset:3072
    buffer_load_dwordx4 v[80:83], v254, s[24:27], s12 offen offset:0
    buffer_load_dwordx4 v[84:87], v254, s[24:27], s12 offen offset:3072
    s_nop 0
    s_barrier
    ds_read_b64_tr_b16 a[0:1], v216 offset:49152
    ds_read_b64_tr_b16 a[2:3], v216 offset:54528
    ds_read_b64_tr_b16 a[4:5], v216 offset:49160
    ds_read_b64_tr_b16 a[6:7], v216 offset:54536
    ds_read_b64_tr_b16 a[8:9], v216 offset:49216
    ds_read_b64_tr_b16 a[10:11], v216 offset:54592
    ds_read_b64_tr_b16 a[12:13], v216 offset:49224
    ds_read_b64_tr_b16 a[14:15], v216 offset:54600
    ds_read_b64_tr_b16 a[16:17], v218 offset:49280
    ds_read_b64_tr_b16 a[18:19], v218 offset:54656
    ds_read_b64_tr_b16 a[20:21], v216 offset:49312
    ds_read_b64_tr_b16 a[22:23], v216 offset:54688
    ds_read_b64_tr_b16 a[24:25], v216 offset:49320
    ds_read_b64_tr_b16 a[26:27], v216 offset:54696
    ds_read_b64_tr_b16 a[28:29], v216 offset:49376
    ds_read_b64_tr_b16 a[30:31], v216 offset:54752
    ds_read_b64_tr_b16 a[32:33], v216 offset:49384
    ds_read_b64_tr_b16 a[34:35], v216 offset:54760
    ds_read_b64_tr_b16 a[36:37], v218 offset:49440
    ds_read_b64_tr_b16 a[38:39], v218 offset:54816
    s_mul_i32 s60, s3, 96
    s_nop 0
    s_add_u32 s60, s60, s52
    s_mul_i32 s60, s60, 5120
    s_add_u32 s60, s60, 2097152
    v_lshlrev_b32 v217, 4, v0
    s_waitcnt lgkmcnt(15)
    buffer_store_dwordx4 a[0:3], v217, s[44:47], s60 offen offset:0 sc1
    buffer_store_dwordx4 a[4:7], v217, s[44:47], s60 offen offset:1024 sc1
    s_waitcnt lgkmcnt(14)
    buffer_store_dwordx4 a[8:11], v217, s[44:47], s60 offen offset:2048 sc1
    s_waitcnt lgkmcnt(12)
    buffer_store_dwordx4 a[12:15], v217, s[44:47], s60 offen offset:3072 sc1
    s_add_u32 s60, s60, 4096
    s_waitcnt lgkmcnt(10)
    buffer_store_dwordx4 a[16:19], v217, s[44:47], s60 offen offset:0 sc1
    s_add_u32 s60, s60, 241664
    s_waitcnt lgkmcnt(8)
    buffer_store_dwordx4 a[20:23], v217, s[44:47], s60 offen offset:0 sc1
    s_waitcnt lgkmcnt(6)
    buffer_store_dwordx4 a[24:27], v217, s[44:47], s60 offen offset:1024 sc1
    s_waitcnt lgkmcnt(4)
    buffer_store_dwordx4 a[28:31], v217, s[44:47], s60 offen offset:2048 sc1
    s_waitcnt lgkmcnt(2)
    buffer_store_dwordx4 a[32:35], v217, s[44:47], s60 offen offset:3072 sc1
    s_add_u32 s60, s60, 4096
    s_waitcnt lgkmcnt(0)
    buffer_store_dwordx4 a[36:39], v217, s[44:47], s60 offen offset:0 sc1
    s_add_u32 s60, s60, 241664
    s_branch .Lr2
.Ls2:
    buffer_load_dwordx4 v[176:179], v230, s[32:35], s71 offen
    s_add_u32 s71, s71, s53
    buffer_load_dwordx4 v[180:183], v230, s[32:35], s71 offen
    s_add_u32 s71, s71, s53
    buffer_load_dwordx4 v[184:187], v230, s[32:35], s71 offen
    s_add_u32 s71, s71, s53
    buffer_load_dwordx4 v[188:191], v230, s[32:35], s71 offen
    s_add_u32 s71, s71, s53
    buffer_load_dwordx4 v[192:195], v230, s[32:35], s71 offen
    s_add_u32 s71, s71, s53
    buffer_load_dwordx4 v[196:199], v230, s[32:35], s71 offen
    s_add_u32 s71, s71, s53
    buffer_load_dwordx4 v[200:203], v230, s[32:35], s71 offen
    s_add_u32 s71, s71, s53
    buffer_load_dwordx4 v[204:207], v230, s[32:35], s71 offen
    s_add_u32 s71, s71, s53
    buffer_load_dwordx4 v[208:211], v230, s[32:35], s71 offen
    s_add_u32 s71, s71, s53
    buffer_load_dwordx4 v[212:215], v230, s[32:35], s71 offen
    s_add_u32 s71, s71, s53
    v_mov_b32 v220, 0
    v_mov_b32 v221, 0
    v_mov_b32 v222, 0
    v_mov_b32 v223, 0
    v_mov_b32 v224, 0
    v_mov_b32 v225, 0
    v_mov_b32 v226, 0
    v_mov_b32_e64 v227, 0
    s_mov_b32 s64, 0x3f80
    s_mov_b32 s63, 0x3f800000
    s_waitcnt vmcnt(10)
    s_barrier
    s_mov_b32 s23, 1
    s_cmp_lg_u32 s3, 0
    s_cbranch_scc1 .Lnoarr_46
    s_atomic_add s23, s[44:45], s1 offset:2048 glc
.Lnoarr_46:
    v_dot2c_f32_bf16 v220, s64, v136
    v_dot2c_f32_bf16 v221, s63, v136
    v_dot2c_f32_bf16 v222, s64, v137
    v_dot2c_f32_bf16 v223, s63, v137
    v_dot2c_f32_bf16 v224, s64, v138
    v_dot2c_f32_bf16 v225, s63, v138
    v_dot2c_f32_bf16 v226, s64, v139
    v_dot2c_f32_bf16 v227, s63, v139
    v_dot2c_f32_bf16 v220, s64, v140
    v_dot2c_f32_bf16 v221, s63, v140
    v_dot2c_f32_bf16 v222, s64, v141
    v_dot2c_f32_bf16 v223, s63, v141
    v_dot2c_f32_bf16 v224, s64, v142
    v_dot2c_f32_bf16 v225, s63, v142
    v_dot2c_f32_bf16 v226, s64, v143
    v_dot2c_f32_bf16 v227, s63, v143
    v_dot2c_f32_bf16 v220, s64, v144
    v_dot2c_f32_bf16 v221, s63, v144
    v_dot2c_f32_bf16 v222, s64, v145
    v_dot2c_f32_bf16 v223, s63, v145
    v_dot2c_f32_bf16 v224, s64, v146
    v_dot2c_f32_bf16 v225, s63, v146
    v_dot2c_f32_bf16 v226, s64, v147
    v_dot2c_f32_bf16 v227, s63, v147
    v_dot2c_f32_bf16 v220, s64, v148
    v_dot2c_f32_bf16 v221, s63, v148
    v_dot2c_f32_bf16 v222, s64, v149
    v_dot2c_f32_bf16 v223, s63, v149
    v_dot2c_f32_bf16 v224, s64, v150
    v_dot2c_f32_bf16 v225, s63, v150
    v_dot2c_f32_bf16 v226, s64, v151
    v_dot2c_f32_bf16 v227, s63, v151
    v_dot2c_f32_bf16 v220, s64, v152
    v_dot2c_f32_bf16 v221, s63, v152
    v_dot2c_f32_bf16 v222, s64, v153
    v_dot2c_f32_bf16 v223, s63, v153
    v_dot2c_f32_bf16 v224, s64, v154
    v_dot2c_f32_bf16 v225, s63, v154
    v_dot2c_f32_bf16 v226, s64, v155
    v_dot2c_f32_bf16 v227, s63, v155
    v_dot2c_f32_bf16 v220, s64, v156
    v_dot2c_f32_bf16 v221, s63, v156
    v_dot2c_f32_bf16 v222, s64, v157
    v_dot2c_f32_bf16 v223, s63, v157
    v_dot2c_f32_bf16 v224, s64, v158
    v_dot2c_f32_bf16 v225, s63, v158
    v_dot2c_f32_bf16 v226, s64, v159
    v_dot2c_f32_bf16 v227, s63, v159
    v_dot2c_f32_bf16 v220, s64, v160
    v_dot2c_f32_bf16 v221, s63, v160
    v_dot2c_f32_bf16 v222, s64, v161
    v_dot2c_f32_bf16 v223, s63, v161
    v_dot2c_f32_bf16 v224, s64, v162
    v_dot2c_f32_bf16 v225, s63, v162
    v_dot2c_f32_bf16 v226, s64, v163
    v_dot2c_f32_bf16 v227, s63, v163
    v_dot2c_f32_bf16 v220, s64, v164
    v_dot2c_f32_bf16 v221, s63, v164
    v_dot2c_f32_bf16 v222, s64, v165
    v_dot2c_f32_bf16 v223, s63, v165
    v_dot2c_f32_bf16 v224, s64, v166
    v_dot2c_f32_bf16 v225, s63, v166
    v_dot2c_f32_bf16 v226, s64, v167
    v_dot2c_f32_bf16 v227, s63, v167
    v_dot2c_f32_bf16 v220, s64, v168
    v_dot2c_f32_bf16 v221, s63, v168
    v_dot2c_f32_bf16 v222, s64, v169
    v_dot2c_f32_bf16 v223, s63, v169
    v_dot2c_f32_bf16 v224, s64, v170
    v_dot2c_f32_bf16 v225, s63, v170
    v_dot2c_f32_bf16 v226, s64, v171
    v_dot2c_f32_bf16 v227, s63, v171
    v_dot2c_f32_bf16 v220, s64, v172
    v_dot2c_f32_bf16 v221, s63, v172
    v_dot2c_f32_bf16 v222, s64, v173
    v_dot2c_f32_bf16 v223, s63, v173
    v_dot2c_f32_bf16 v224, s64, v174
    v_dot2c_f32_bf16 v225, s63, v174
    v_dot2c_f32_bf16 v226, s64, v175
    v_dot2c_f32_bf16 v227, s63, v175
    s_waitcnt lgkmcnt(0)
    s_cmp_lg_u32 s23, 11
    s_cbranch_scc1 .Lnotlast_47
    s_mov_b32 exec_lo, 15
    s_mov_b32 exec_hi, 15
    v_lshlrev_b32 v216, 8, v0
    s_mov_b32 s67, 4096
    buffer_atomic_add v248, v216, s[44:47], s67 offen sc1
    s_mov_b64 exec, -1
.Lnotlast_47:
    s_waitcnt vmcnt(9)
    v_dot2c_f32_bf16 v220, s64, v176
    v_dot2c_f32_bf16 v221, s63, v176
    v_dot2c_f32_bf16 v222, s64, v177
    v_dot2c_f32_bf16 v223, s63, v177
    v_and_b32 v250, 56, v0
    v_add_u32 v250, s68, v250
    v_subrev_u32 v249, 640, v250
    v_min_u32_e64 v250, v250, v249
    v_mad_u32_u24 v254, v250, s15, v253
    s_add_u32 s68, s68, 128
    buffer_load_dwordx4 v[8:11], v254, s[24:27], 0 offen offset:0
    v_dot2c_f32_bf16 v224, s64, v178
    v_dot2c_f32_bf16 v225, s63, v178
    v_dot2c_f32_bf16 v226, s64, v179
    v_dot2c_f32_bf16 v227, s63, v179
    buffer_load_dwordx4 v[12:15], v254, s[24:27], 0 offen offset:3072
    s_waitcnt vmcnt(10)
    v_dot2c_f32_bf16 v220, s64, v180
    v_dot2c_f32_bf16 v221, s63, v180
    v_dot2c_f32_bf16 v222, s64, v181
    v_dot2c_f32_bf16_e64 v223, s63, v181
    buffer_load_dwordx4 v[16:19], v254, s[24:27], s12 offen offset:0
    v_dot2c_f32_bf16 v224, s64, v182
    v_dot2c_f32_bf16 v225, s63, v182
    v_dot2c_f32_bf16 v226, s64, v183
    v_dot2c_f32_bf16 v227, s63, v183
    buffer_load_dwordx4 v[20:23], v254, s[24:27], s12 offen offset:3072
    s_waitcnt vmcnt(11)
    v_dot2c_f32_bf16 v220, s64, v184
    v_dot2c_f32_bf16 v221, s63, v184
    v_dot2c_f32_bf16 v222, s64, v185
    v_dot2c_f32_bf16_e64 v223, s63, v185
    buffer_load_dwordx4 v[24:27], v254, s[24:27], s13 offen offset:0
    v_dot2c_f32_bf16 v224, s64, v186
    v_dot2c_f32_bf16 v225, s63, v186
    v_dot2c_f32_bf16 v226, s64, v187
    v_dot2c_f32_bf16 v227, s63, v187
    buffer_load_dwordx4 v[28:31], v254, s[24:27], s13 offen offset:3072
    s_waitcnt vmcnt(12)
    v_dot2c_f32_bf16 v220, s64, v188
    v_dot2c_f32_bf16 v221, s63, v188
    v_dot2c_f32_bf16 v222, s64, v189
    v_dot2c_f32_bf16_e64 v223, s63, v189
    buffer_load_dwordx4 v[32:35], v254, s[24:27], s14 offen offset:0
    v_dot2c_f32_bf16 v224, s64, v190
    v_dot2c_f32_bf16 v225, s63, v190
    v_dot2c_f32_bf16 v226, s64, v191
    v_dot2c_f32_bf16 v227, s63, v191
    buffer_load_dwordx4 v[36:39], v254, s[24:27], s14 offen offset:3072
    s_waitcnt vmcnt(13)
    v_dot2c_f32_bf16 v220, s64, v192
    v_dot2c_f32_bf16 v221, s63, v192
    v_dot2c_f32_bf16 v222, s64, v193
    v_dot2c_f32_bf16 v223, s63, v193
    v_and_b32 v250, 56, v0
    v_add_u32_e64 v250, s68, v250
    v_subrev_u32 v249, 640, v250
    v_min_u32_e64 v250, v250, v249
    v_mad_u32_u24 v254, v250, s15, v253
    s_add_u32 s68, s68, 128
    buffer_load_dwordx4 v[40:43], v254, s[24:27], 0 offen offset:0
    v_dot2c_f32_bf16 v224, s64, v194
    v_dot2c_f32_bf16 v225, s63, v194
    v_dot2c_f32_bf16 v226, s64, v195
    v_dot2c_f32_bf16 v227, s63, v195
    buffer_load_dwordx4 v[44:47], v254, s[24:27], 0 offen offset:3072
    s_waitcnt vmcnt(14)
    v_dot2c_f32_bf16 v220, s64, v196
    v_dot2c_f32_bf16 v221, s63, v196
    v_dot2c_f32_bf16 v222, s64, v197
    v_dot2c_f32_bf16_e64 v223, s63, v197
    buffer_load_dwordx4 v[48:51], v254, s[24:27], s12 offen offset:0
    v_dot2c_f32_bf16 v224, s64, v198
    v_dot2c_f32_bf16 v225, s63, v198
    v_dot2c_f32_bf16 v226, s64, v199
    v_dot2c_f32_bf16 v227, s63, v199
    buffer_load_dwordx4 v[52:55], v254, s[24:27], s12 offen offset:3072
    s_waitcnt vmcnt(15)
    v_dot2c_f32_bf16 v220, s64, v200
    v_dot2c_f32_bf16 v221, s63, v200
    v_dot2c_f32_bf16 v222, s64, v201
    v_dot2c_f32_bf16_e64 v223, s63, v201
    buffer_load_dwordx4 v[56:59], v254, s[24:27], s13 offen offset:0
    v_dot2c_f32_bf16 v224, s64, v202
    v_dot2c_f32_bf16 v225, s63, v202
    v_dot2c_f32_bf16 v226, s64, v203
    v_dot2c_f32_bf16 v227, s63, v203
    buffer_load_dwordx4 v[60:63], v254, s[24:27], s13 offen offset:3072
    s_waitcnt vmcnt(16)
    v_dot2c_f32_bf16 v220, s64, v204
    v_dot2c_f32_bf16 v221, s63, v204
    v_dot2c_f32_bf16 v222, s64, v205
    v_dot2c_f32_bf16_e64 v223, s63, v205
    buffer_load_dwordx4 v[64:67], v254, s[24:27], s14 offen offset:0
    v_dot2c_f32_bf16 v224, s64, v206
    v_dot2c_f32_bf16 v225, s63, v206
    v_dot2c_f32_bf16 v226, s64, v207
    v_dot2c_f32_bf16 v227, s63, v207
    buffer_load_dwordx4 v[68:71], v254, s[24:27], s14 offen offset:3072
    s_waitcnt vmcnt(17)
    v_dot2c_f32_bf16 v220, s64, v208
    v_dot2c_f32_bf16 v221, s63, v208
    v_dot2c_f32_bf16 v222, s64, v209
    v_dot2c_f32_bf16 v223, s63, v209
    v_and_b32 v250, 56, v0
    v_add_u32_e64 v250, s68, v250
    v_subrev_u32 v249, 640, v250
    v_min_u32_e64 v250, v250, v249
    v_mad_u32_u24 v254, v250, s15, v253
    s_add_u32 s68, s68, 128
    buffer_load_dwordx4 v[72:75], v254, s[24:27], 0 offen offset:0
    v_dot2c_f32_bf16 v224, s64, v210
    v_dot2c_f32_bf16 v225, s63, v210
    v_dot2c_f32_bf16 v226, s64, v211
    v_dot2c_f32_bf16 v227, s63, v211
    buffer_load_dwordx4 v[76:79], v254, s[24:27], 0 offen offset:3072
    s_waitcnt vmcnt(18)
    v_dot2c_f32_bf16 v220, s64, v212
    v_dot2c_f32_bf16 v221, s63, v212
    v_dot2c_f32_bf16 v222, s64, v213
    v_dot2c_f32_bf16_e64 v223, s63, v213
    buffer_load_dwordx4 v[80:83], v254, s[24:27], s12 offen offset:0
    v_dot2c_f32_bf16 v224, s64, v214
    v_dot2c_f32_bf16 v225, s63, v214
    v_dot2c_f32_bf16 v226, s64, v215
    v_dot2c_f32_bf16 v227, s63, v215
    buffer_load_dwordx4 v[84:87], v254, s[24:27], s12 offen offset:3072
    v_lshlrev_b32_e64 v5, 5, v1
    ds_write_b128 v5, v[220:223] offset:49152
    ds_write_b128 v5, v[224:227] offset:49168
    s_waitcnt lgkmcnt(0)
    s_barrier
    v_bfe_u32 v6, v0, 1, 4
    v_and_b32 v7, 32, v0
    v_add_u32 v6, v6, v7
    v_and_b32_e64 v7, 1, v0
    v_lshl_add_u32 v6, v7, 4, v6
    v_lshlrev_b32_e64 v6, 2, v6
    ds_read2st64_b32 v[136:137], v6 offset0:192 offset1:193
    ds_read2st64_b32 v[138:139], v6 offset0:194 offset1:195
    ds_read2st64_b32 v[140:141], v6 offset0:196 offset1:197
    ds_read2st64_b32 v[142:143], v6 offset0:198 offset1:199
    ds_read2st64_b32 v[144:145], v6 offset0:200 offset1:201
    ds_read2st64_b32 v[146:147], v6 offset0:202 offset1:203
    ds_read2st64_b32 v[148:149], v6 offset0:204 offset1:205
    ds_read2st64_b32 v[150:151], v6 offset0:206 offset1:207
    ds_read2st64_b32 v[152:153], v6 offset0:208 offset1:209
    ds_read2st64_b32 v[154:155], v6 offset0:210 offset1:211
    ds_read2st64_b32 v[156:157], v6 offset0:212 offset1:213
    ds_read2st64_b32 v[158:159], v6 offset0:214 offset1:215
    ds_read2st64_b32 v[160:161], v6 offset0:216 offset1:217
    ds_read2st64_b32 v[162:163], v6 offset0:218 offset1:219
    ds_read2st64_b32 v[164:165], v6 offset0:220 offset1:221
    ds_read2st64_b32 v[166:167], v6 offset0:222 offset1:223
    s_waitcnt lgkmcnt(14)
    v_pk_add_f32 v[136:137], v[136:137], v[138:139]
    s_waitcnt lgkmcnt(13)
    v_pk_add_f32 v[136:137], v[136:137], v[140:141]
    s_waitcnt lgkmcnt(12)
    v_pk_add_f32 v[136:137], v[136:137], v[142:143]
    s_waitcnt lgkmcnt(11)
    v_pk_add_f32 v[136:137], v[136:137], v[144:145]
    s_waitcnt lgkmcnt(10)
    v_pk_add_f32 v[136:137], v[136:137], v[146:147]
    s_waitcnt lgkmcnt(9)
    v_pk_add_f32 v[136:137], v[136:137], v[148:149]
    s_waitcnt lgkmcnt(8)
    v_pk_add_f32 v[136:137], v[136:137], v[150:151]
    s_waitcnt lgkmcnt(7)
    v_pk_add_f32 v[136:137], v[136:137], v[152:153]
    s_waitcnt lgkmcnt(6)
    v_pk_add_f32 v[136:137], v[136:137], v[154:155]
    s_waitcnt lgkmcnt(5)
    v_pk_add_f32 v[136:137], v[136:137], v[156:157]
    s_waitcnt lgkmcnt(4)
    v_pk_add_f32 v[136:137], v[136:137], v[158:159]
    s_waitcnt lgkmcnt(3)
    v_pk_add_f32 v[136:137], v[136:137], v[160:161]
    s_waitcnt lgkmcnt(2)
    v_pk_add_f32 v[136:137], v[136:137], v[162:163]
    s_waitcnt lgkmcnt(1)
    v_pk_add_f32 v[136:137], v[136:137], v[164:165]
    s_waitcnt lgkmcnt(0)
    v_pk_add_f32 v[136:137], v[136:137], v[166:167]
    v_add_f32 v136, v136, v137
    v_cvt_pk_bf16_f32 v216, v136, v136
    v_lshlrev_b32 v7, 16, v216
    v_sub_f32 v7, v136, v7
    v_cvt_pk_bf16_f32 v217, v7, v7
    s_lshl_b32 s60, s75, 9
    s_add_u32 s60, s60, 65536
    v_lshlrev_b32 v6, 3, v0
    s_cmp_lg_u32 s3, 0
    s_cbranch_scc1 .Lr2
    buffer_store_dwordx2 v[216:217], v6, s[44:47], s60 offen sc1
.Lr2:
    s_lshr_b32 s60, s52, 5
    s_and_b32 s61, s52, 15
    s_lshl4_add_u32 s60, s60, s61
    s_and_b32 s61, s52, 16
    s_lshl2_add_u32 s60, s61, s60
    s_lshl_b32 s60, s60, 7
    s_add_u32 s60, s60, 16384
    v_mov_b32 v4, 0
    v_and_b32 v5, 31, v0
    v_lshlrev_b32 v5, 2, v5
    s_cmp_lg_u32 s3, 1
    s_cbranch_scc1 .Lnof3_48
    buffer_store_dword v4, v5, s[44:47], s60 offen sc1
.Lnof3_48:
    s_lshr_b32 s60, s52, 3
    s_mul_i32 s60, s60, 86
    s_and_b32 s61, s52, 7
    s_lshl_b32 s61, s61, 10
    s_add_u32 s60, s60, s61
    v_mov_b32 v220, 0
    v_mov_b32 v221, 0
    v_mov_b32 v222, 0
    v_mov_b32 v223, 0
    v_lshrrev_b32 v6, 2, v1
    v_add_u32_e64 v6, 0, v6
    v_min_u32 v6, 85, v6
    v_add_u32_e64 v6, s60, v6
    v_mul_u32_u24 v6, 320, v6
    v_add_u32 v6, 160, v6
    v_and_b32 v6, -64, v6
    v_and_b32_e64 v7, 3, v0
    v_lshl_add_u32 v6, v7, 4, v6
    buffer_store_dwordx4 v[220:223], v6, s[36:39], 0 offen sc1
    v_lshrrev_b32 v6, 2, v1
    v_add_u32 v6, 64, v6
    v_min_u32 v6, 85, v6
    v_add_u32_e64 v6, s60, v6
    v_mul_u32_u24 v6, 320, v6
    v_add_u32 v6, 160, v6
    v_and_b32 v6, -64, v6
    v_and_b32_e64 v7, 3, v0
    v_lshl_add_u32 v6, v7, 4, v6
    buffer_store_dwordx4 v[220:223], v6, s[36:39], 0 offen sc1
    v_mov_b32_e64 v2, -1
    v_mov_b32 v3, -1
    s_lshl_b32 s73, s56, 8
    s_add_u32 s73, s73, 131072
    s_mov_b32 exec_hi, 0
    buffer_store_dwordx2 v[2:3], v251, s[44:47], s73 offen sc1
    s_mov_b32 exec_hi, -1
    buffer_load_dwordx4 v[88:91], v254, s[24:27], s13 offen offset:0
    buffer_load_dwordx4 v[92:95], v254, s[24:27], s13 offen offset:3072
    buffer_load_dwordx4 v[96:99], v254, s[24:27], s14 offen offset:0
    buffer_load_dwordx4 v[100:103], v254, s[24:27], s14 offen offset:3072
    v_and_b32 v250, 56, v0
    v_add_u32 v250, s68, v250
    v_subrev_u32 v249, 640, v250
    v_min_u32_e64 v250, v250, v249
    v_mad_u32_u24 v254, v250, s15, v253
    s_add_u32 s68, s68, 128
    buffer_load_dwordx4 v[104:107], v254, s[24:27], 0 offen offset:0
    buffer_load_dwordx4 v[108:111], v254, s[24:27], 0 offen offset:3072
    buffer_load_dwordx4 v[112:115], v254, s[24:27], s12 offen offset:0
    buffer_load_dwordx4 v[116:119], v254, s[24:27], s12 offen offset:3072
    buffer_load_dwordx4 v[120:123], v254, s[24:27], s13 offen offset:0
    buffer_load_dwordx4 v[124:127], v254, s[24:27], s13 offen offset:3072
    buffer_load_dwordx4 v[128:131], v254, s[24:27], s14 offen offset:0
    buffer_load_dwordx4 v[132:135], v254, s[24:27], s14 offen offset:3072
    s_add_u32 s64, s1, 4096
    s_add_u32 s18, s64, 3072
    s_waitcnt vmcnt(12)
    s_waitcnt lgkmcnt(0)
    s_barrier
    s_mov_b32 s23, 1
    s_mov_b32 s53, 1
    s_cmp_lg_u32 s3, 0
    s_nop 0
    s_cbranch_scc1 .Lnoarr_49
    s_atomic_add s23, s[44:45], s1 offset:5120 glc
    s_atomic_add s53, s[44:45], s1 offset:3072 glc
.Lnoarr_49:
    buffer_load_dword v1, off, s[44:47], s64 sc1
    s_lshr_b32 s60, s3, 1
    s_lshl_b32 s60, s60, 12
    s_and_b32 s61, s3, 1
    s_lshl_b32 s61, s61, 7
    s_add_u32 s60, s60, s61
    v_lshrrev_b32 v250, 3, v0
    v_lshl_add_u32 v250, v250, 9, s60
    v_and_b32_e64 v249, 1, v0
    v_lshl_add_u32 v250, v249, 6, v250
    v_bfe_u32 v249, v0, 1, 2
    s_mov_b32 s60, 40976
    v_mad_u32_u24 v232, v249, s60, v250
    v_xor_b32 v233, 16, v232
    v_xor_b32 v234, 32, v232
    v_xor_b32_e64 v243, 48, v232
    s_mov_b32 s16, 0x05040100
    s_mov_b32 s17, 0x07060302
    v_perm_b32 v200, v12, v8, s16
    v_perm_b32 v201, v20, v16, s16
    v_perm_b32 v202, v28, v24, s16
    v_perm_b32 v203, v36, v32, s16
    ds_write_b128 v232, v[200:203] offset:0
    v_and_b32 v250, 56, v0
    v_add_u32 v250, s68, v250
    v_subrev_u32 v249, 640, v250
    v_min_u32_e64 v250, v250, v249
    v_mad_u32_u24 v254, v250, s15, v253
    s_add_u32 s68, s68, 128
    buffer_load_dwordx4 v[136:139], v254, s[24:27], 0 offen offset:0
    v_perm_b32 v204, v12, v8, s17
    v_perm_b32 v205, v20, v16, s17
    v_perm_b32 v206, v28, v24, s17
    v_perm_b32 v207, v36, v32, s17
    ds_write_b128 v233, v[204:207] offset:0
    buffer_load_dwordx4 v[140:143], v254, s[24:27], 0 offen offset:3072
    v_perm_b32 v208, v13, v9, s16
    v_perm_b32 v209, v21, v17, s16
    v_perm_b32 v210, v29, v25, s16
    v_perm_b32 v211, v37, v33, s16
    ds_write_b128 v234, v[208:211] offset:0
    buffer_load_dwordx4 v[144:147], v254, s[24:27], s12 offen offset:0
    v_perm_b32 v212, v13, v9, s17
    v_perm_b32 v213, v21, v17, s17
    v_perm_b32 v214, v29, v25, s17
    v_perm_b32 v215, v37, v33, s17
    ds_write_b128 v243, v[212:215] offset:0
    buffer_load_dwordx4 v[148:151], v254, s[24:27], s12 offen offset:3072
    v_perm_b32 v200, v14, v10, s16
    v_perm_b32 v201, v22, v18, s16
    v_perm_b32 v202, v30, v26, s16
    v_perm_b32 v203, v38, v34, s16
    ds_write_b128 v232, v[200:203] offset:256
    buffer_load_dwordx4 v[152:155], v254, s[24:27], s13 offen offset:0
    v_perm_b32 v204, v14, v10, s17
    v_perm_b32 v205, v22, v18, s17
    v_perm_b32 v206, v30, v26, s17
    v_perm_b32 v207, v38, v34, s17
    ds_write_b128 v233, v[204:207] offset:256
    buffer_load_dwordx4 v[156:159], v254, s[24:27], s13 offen offset:3072
    v_perm_b32 v208, v15, v11, s16
    v_perm_b32 v209, v23, v19, s16
    v_perm_b32 v210, v31, v27, s16
    v_perm_b32 v211, v39, v35, s16
    ds_write_b128 v234, v[208:211] offset:256
    buffer_load_dwordx4 v[160:163], v254, s[24:27], s14 offen offset:0
    v_perm_b32 v212, v15, v11, s17
    v_perm_b32 v213, v23, v19, s17
    v_perm_b32 v214, v31, v27, s17
    v_perm_b32 v215, v39, v35, s17
    ds_write_b128 v243, v[212:215] offset:256
    buffer_load_dwordx4 v[164:167], v254, s[24:27], s14 offen offset:3072
    s_waitcnt lgkmcnt(0)
    s_cmp_lg_u32 s53, 11
    s_cbranch_scc1 .Lnotlast_50
    s_mov_b32 exec_lo, 15
    s_mov_b32 exec_hi, 15
    v_lshlrev_b32 v216, 8, v0
    s_mov_b32 s67, 7168
    buffer_atomic_add v248, v216, s[44:47], s67 offen sc1
    s_mov_b64 exec, -1
.Lnotlast_50:
    s_cmp_lg_u32 s23, 31
    s_cbranch_scc1 .Lnotlast_51
    s_mov_b32 exec_lo, 15
    s_mov_b32 exec_hi, 15
    v_lshlrev_b32 v216, 8, v0
    s_mov_b32 s67, 6144
    buffer_atomic_add v248, v216, s[44:47], s67 offen sc1
    s_mov_b64 exec, -1
.Lnotlast_51:
    s_waitcnt vmcnt(8)
    v_readfirstlane_b32 s67, v1
    s_nop 1
    s_cmp_lt_u32 s67, 8
    s_cbranch_scc1 .Lslow_52
.Lback_53:
    v_perm_b32 v200, v44, v40, s16
    v_perm_b32 v201, v52, v48, s16
    v_perm_b32 v202, v60, v56, s16
    v_perm_b32 v203, v68, v64, s16
    ds_write_b128 v232, v[200:203] offset:8192
    s_and_b32 s60, s51, 7
    s_lshl2_add_u32 s60, s60, s3
    s_mul_i32 s60, s60, 61440
    v_lshl_add_u32 v247, v0, 4, s60
    v_add_u32 v255, 0x1000, v247
    v_lshlrev_b32_e64 v4, 4, v0
    v_perm_b32 v204, v44, v40, s17
    v_perm_b32 v205, v52, v48, s17
    v_perm_b32 v206, v60, v56, s17
    v_perm_b32 v207, v68, v64, s17
    ds_write_b128 v233, v[204:207] offset:8192
    v_xor_b32_e64 v250, 16, v4
    v_add_u32 v5, 40960, v250
    v_xor_b32_e64 v250, 32, v4
    v_add_u32 v6, 81920, v250
    v_xor_b32_e64 v250, 48, v4
    v_add_u32 v7, 122880, v250
    buffer_load_dwordx4 a[160:163], v252, s[44:47], s69 offen sc1
    v_perm_b32 v208, v45, v41, s16
    v_perm_b32 v209, v53, v49, s16
    v_perm_b32 v210, v61, v57, s16
    v_perm_b32 v211, v69, v65, s16
    ds_write_b128 v234, v[208:211] offset:8192
    v_lshl_add_u32 v253, s3, 10, v5
    s_lshl2_add_u32 s60, s55, s3
    s_lshl_b32 s61, s60, 8
    v_and_b32 v250, 15, v0
    v_lshlrev_b32 v3, 4, v250
    v_add_u32_e64 v250, s61, v3
    v_perm_b32 v212, v45, v41, s17
    v_perm_b32 v213, v53, v49, s17
    v_perm_b32 v214, v61, v57, s17
    v_perm_b32 v215, v69, v65, s17
    ds_write_b128 v243, v[212:215] offset:8192
    v_lshrrev_b32_e64 v249, 4, v0
    s_mov_b32 s61, 16384
    v_mad_u32_u24 v1, v249, s61, v250
    v_lshl_add_u32 v3, v249, 9, v3
    s_nop 0
    s_and_b32 s64, s60, 7
    s_mul_i32 s61, s64, 196608
    s_add_u32 s74, s69, 40960
    buffer_load_dwordx4 a[164:167], v252, s[44:47], s74 offen sc1
    v_perm_b32 v200, v46, v42, s16
    v_perm_b32 v201, v54, v50, s16
    v_perm_b32 v202, v62, v58, s16
    v_perm_b32 v203, v70, v66, s16
    ds_write_b128 v232, v[200:203] offset:8448
    s_bfe_u32 s64, s60, 0x20003
    s_lshl_b32 s64, s64, 22
    s_add_u32 s61, s61, s64
    s_lshr_b32 s64, s60, 5
    s_lshl_b32 s64, s64, 13
    s_add_u32 s61, s61, s64
    s_add_u32 s69, s69, 4096
    s_sub_u32 s74, s69, 40960
    s_cselect_b32 s69, s69, s74
    buffer_load_dwordx4 a[168:171], v252, s[44:47], s69 offen sc1
    v_perm_b32 v204, v46, v42, s17
    v_perm_b32 v205, v54, v50, s17
    v_perm_b32 v206, v62, v58, s17
    v_perm_b32 v207, v70, v66, s17
    ds_write_b128 v233, v[204:207] offset:8448
    v_lshl_add_u32 v2, v0, 4, s61
    s_lshr_b32 s54, s60, 1
    s_and_b32 s64, s54, 16
    s_mul_i32 s64, s64, 3
    s_add_u32 s54, s54, s64
    s_nop 0
    s_lshl_b32 s54, s54, 7
    v_perm_b32 v208, v47, v43, s16
    v_perm_b32 v209, v55, v51, s16
    v_perm_b32 v210, v63, v59, s16
    v_perm_b32 v211, v71, v67, s16
    ds_write_b128 v234, v[208:211] offset:8448
    s_add_u32 s54, s54, 16384
    s_lshr_b32 s61, s51, 3
    s_lshl2_add_u32 s53, s50, s61
    s_lshl_b32 s52, s53, 1
    s_and_b32 s64, s53, 16
    s_nop 0
    s_mul_i32 s64, s64, 3
    s_add_u32 s74, s69, 40960
    buffer_load_dwordx4 a[172:175], v252, s[44:47], s74 offen sc1
    v_perm_b32 v212, v47, v43, s17
    v_perm_b32 v213, v55, v51, s17
    v_perm_b32 v214, v63, v59, s17
    v_perm_b32 v215, v71, v67, s17
    ds_write_b128 v243, v[212:215] offset:8448
    s_add_u32 s53, s53, s64
    s_lshl_b32 s53, s53, 7
    s_add_u32 s53, s53, 16384
    s_add_u32 s60, s59, 0
    s_and_b32 s60, s60, 3
    s_mul_i32 s61, s60, 655360
    s_add_u32 s69, s69, 4096
    s_sub_u32 s74, s69, 40960
    s_nop 0
    s_cselect_b32 s69, s69, s74
    buffer_load_dwordx4 a[176:179], v252, s[44:47], s69 offen sc1
    v_perm_b32 v200, v76, v72, s16
    v_perm_b32 v201, v84, v80, s16
    v_perm_b32 v202, v92, v88, s16
    v_perm_b32 v203, v100, v96, s16
    ds_write_b128 v232, v[200:203] offset:16384
    s_add_u32 s61, s61, 16777216
    s_nop 0
    s_cmp_lt_u32 s60, 3
    s_cselect_b32 s4, s61, 9437184
    s_add_u32 s60, s59, 1
    s_and_b32 s60, s60, 3
    s_mul_i32 s61, s60, 655360
    s_add_u32 s61, s61, 16777216
    v_perm_b32 v204, v76, v72, s17
    v_perm_b32 v205, v84, v80, s17
    v_perm_b32 v206, v92, v88, s17
    v_perm_b32 v207, v100, v96, s17
    ds_write_b128 v233, v[204:207] offset:16384
    s_cmp_lt_u32 s60, 3
    s_cselect_b32 s5, s61, 9437184
    s_add_u32 s60, s59, 2
    s_and_b32 s60, s60, 3
    s_mul_i32 s61, s60, 655360
    s_add_u32 s61, s61, 16777216
    s_cmp_lt_u32 s60, 3
    s_cselect_b32 s6, s61, 9437184
    s_add_u32 s74, s69, 40960
    buffer_load_dwordx4 a[180:183], v252, s[44:47], s74 offen sc1
    v_perm_b32 v208, v77, v73, s16
    v_perm_b32 v209, v85, v81, s16
    v_perm_b32 v210, v93, v89, s16
    v_perm_b32 v211, v101, v97, s16
    ds_write_b128 v234, v[208:211] offset:16384
    s_add_u32 s60, s59, 3
    s_and_b32 s60, s60, 3
    s_mul_i32 s61, s60, 655360
    s_add_u32 s61, s61, 16777216
    s_cmp_lt_u32 s60, 3
    s_cselect_b32 s7, s61, 9437184
    v_and_b32 v250, 3, v0
    s_add_u32 s69, s69, 4096
    s_sub_u32 s74, s69, 40960
    s_nop 0
    s_cselect_b32 s69, s69, s74
    buffer_load_dwordx4 a[184:187], v252, s[44:47], s69 offen sc1
    v_perm_b32 v212, v77, v73, s17
    v_perm_b32 v213, v85, v81, s17
    v_perm_b32 v214, v93, v89, s17
    v_perm_b32 v215, v101, v97, s17
    ds_write_b128 v243, v[212:215] offset:16384
    v_bfe_u32 v249, v0, 2, 1
    v_lshl_add_u32 v250, v249, 3, v250
    v_bfe_u32 v249, v0, 4, 1
    v_lshl_add_u32 v250, v249, 2, v250
    v_lshlrev_b32_e64 v250, 4, v250
    v_bfe_u32 v249, v0, 3, 1
    v_perm_b32 v200, v78, v74, s16
    v_perm_b32 v201, v86, v82, s16
    v_perm_b32 v202, v94, v90, s16
    v_perm_b32 v203, v102, v98, s16
    ds_write_b128 v232, v[200:203] offset:16640
    s_nop 0
    s_movk_i32 s61, 12288
    v_mad_u32_u24 v246, v249, s61, v250
    s_mov_b32 s72, 0x3f803f80
    s_mov_b32 s75, 1
    s_lshl_b32 s62, s57, 7
    s_add_u32 s62, s62, 65536
    s_add_u32 s74, s69, 40960
    buffer_load_dwordx4 a[188:191], v252, s[44:47], s74 offen sc1
    v_perm_b32 v204, v78, v74, s17
    v_perm_b32 v205, v86, v82, s17
    v_perm_b32 v206, v94, v90, s17
    v_perm_b32 v207, v102, v98, s17
    ds_write_b128 v233, v[204:207] offset:16640
    s_lshl_b32 s63, s58, 7
    s_add_u32 s63, s63, 65536
    s_and_b32 s60, s57, -8
    s_add_u32 s57, s57, s60
    s_lshl_b32 s57, s57, 10
    s_add_u32 s57, s57, 20971520
    s_add_u32 s69, s69, 4096
    s_sub_u32 s74, s69, 40960
    s_nop 0
    s_cselect_b32 s69, s69, s74
    buffer_load_dwordx4 a[192:195], v252, s[44:47], s69 offen sc1
    v_perm_b32 v208, v79, v75, s16
    v_perm_b32 v209, v87, v83, s16
    v_perm_b32 v210, v95, v91, s16
    v_perm_b32 v211, v103, v99, s16
    ds_write_b128 v234, v[208:211] offset:16640
    s_and_b32 s60, s58, -8
    s_add_u32 s58, s58, s60
    s_lshl_b32 s58, s58, 10
    s_add_u32 s58, s58, 20971520
    s_and_b32 s64, s52, 7
    s_mul_i32 s66, s64, 196608
    v_perm_b32 v212, v79, v75, s17
    v_perm_b32 v213, v87, v83, s17
    v_perm_b32 v214, v95, v91, s17
    v_perm_b32 v215, v103, v99, s17
    ds_write_b128 v243, v[212:215] offset:16640
    s_bfe_u32 s64, s52, 0x20003
    s_lshl_b32 s64, s64, 22
    s_add_u32 s66, s66, s64
    s_lshr_b32 s64, s52, 5
    s_lshl_b32 s64, s64, 13
    s_nop 0
    s_add_u32 s66, s66, s64
    s_add_u32 s74, s69, 40960
    buffer_load_dwordx4 a[196:199], v252, s[44:47], s74 offen sc1
    v_perm_b32 v200, v108, v104, s16
    v_perm_b32 v201, v116, v112, s16
    v_perm_b32 v202, v124, v120, s16
    v_perm_b32 v203, v132, v128, s16
    ds_write_b128 v232, v[200:203] offset:24576
    s_mul_i32 s65, s3, 49152
    s_add_u32 s65, s65, s66
    s_xor_b32 s60, s3, 0
    s_lshr_b32 s61, s60, 1
    s_mul_i32 s61, s61, 196608
    s_and_b32 s60, s60, 1
    s_add_u32 s69, s69, 4096
    s_sub_u32 s74, s69, 40960
    s_nop 0
    s_cselect_b32 s69, s69, s74
    buffer_load_dwordx4 a[200:203], v252, s[44:47], s69 offen sc1
    v_perm_b32 v204, v108, v104, s17
    v_perm_b32 v205, v116, v112, s17
    v_perm_b32 v206, v124, v120, s17
    v_perm_b32 v207, v132, v128, s17
    ds_write_b128 v233, v[204:207] offset:24576
    s_lshl_b32 s60, s60, 8
    s_add_u32 s60, s60, s65
    s_add_u32 s8, s61, s60
    s_xor_b32 s60, s3, 1
    s_nop 0
    s_lshr_b32 s61, s60, 1
    s_mul_i32 s61, s61, 196608
    v_perm_b32 v208, v109, v105, s16
    v_perm_b32 v209, v117, v113, s16
    v_perm_b32 v210, v125, v121, s16
    v_perm_b32 v211, v133, v129, s16
    ds_write_b128 v234, v[208:211] offset:24576
    s_and_b32 s60, s60, 1
    s_lshl_b32 s60, s60, 8
    s_add_u32 s60, s60, s65
    s_add_u32 s9, s61, s60
    s_xor_b32 s60, s3, 2
    s_lshr_b32 s61, s60, 1
    s_add_u32 s74, s69, 40960
    buffer_load_dwordx4 a[204:207], v252, s[44:47], s74 offen sc1
    v_perm_b32 v212, v109, v105, s17
    v_perm_b32 v213, v117, v113, s17
    v_perm_b32 v214, v125, v121, s17
    v_perm_b32 v215, v133, v129, s17
    ds_write_b128 v243, v[212:215] offset:24576
    s_mul_i32 s61, s61, 196608
    s_and_b32 s60, s60, 1
    s_lshl_b32 s60, s60, 8
    s_add_u32 s60, s60, s65
    s_add_u32 s10, s61, s60
    s_xor_b32 s60, s3, 3
    s_add_u32 s69, s69, 4096
    s_sub_u32 s74, s69, 40960
    s_cselect_b32 s69, s69, s74
    buffer_load_dwordx4 a[208:211], v252, s[44:47], s69 offen sc1
    v_perm_b32 v200, v110, v106, s16
    v_perm_b32 v201, v118, v114, s16
    v_perm_b32 v202, v126, v122, s16
    v_perm_b32 v203, v134, v130, s16
    ds_write_b128 v232, v[200:203] offset:24832
    s_nop 0
    s_lshr_b32 s61, s60, 1
    s_mul_i32 s61, s61, 196608
    s_and_b32 s60, s60, 1
    s_lshl_b32 s60, s60, 8
    s_add_u32 s60, s60, s65
    s_add_u32 s11, s61, s60
    v_perm_b32 v204, v110, v106, s17
    v_perm_b32 v205, v118, v114, s17
    v_perm_b32 v206, v126, v122, s17
    v_perm_b32 v207, v134, v130, s17
    ds_write_b128 v233, v[204:207] offset:24832
    s_lshr_b32 s60, s3, 1
    s_add_u32 s60, s60, s52
    s_lshl_b32 s20, s60, 8
    s_and_b32 s64, s3, 1
    s_lshl3_add_u32 s20, s64, s20
    s_and_b32 s65, s51, 7
    s_add_u32 s74, s69, 40960
    buffer_load_dwordx4 a[212:215], v252, s[44:47], s74 offen sc1
    v_perm_b32 v208, v111, v107, s16
    v_perm_b32 v209, v119, v115, s16
    v_perm_b32 v210, v127, v123, s16
    v_perm_b32 v211, v135, v131, s16
    ds_write_b128 v234, v[208:211] offset:24832
    s_mul_i32 s66, s65, 327680
    s_add_u32 s20, s20, s66
    s_mov_b32 s66, 16777216
    s_cmp_lt_u32 s65, 6
    s_cselect_b32 s66, s66, 7471104
    s_add_u32 s20, s20, s66
    s_mov_b32 s22, 16384
    s_add_u32 s69, s69, 4096
    s_sub_u32 s74, s69, 40960
    s_cselect_b32 s69, s69, s74
    buffer_load_dwordx4 a[216:219], v252, s[44:47], s69 offen sc1
    v_perm_b32 v212, v111, v107, s17
    v_perm_b32 v213, v119, v115, s17
    v_perm_b32 v214, v127, v123, s17
    v_perm_b32 v215, v135, v131, s17
    ds_write_b128 v243, v[212:215] offset:24832
    s_lshr_b32 s21, s52, 3
    s_lshl_b32 s21, s21, 8
    s_and_b32 s66, s60, 3
    s_lshl2_add_u32 s21, s66, s21
    s_bfe_u32 s66, s52, 0x10002
    s_lshl1_add_u32 s21, s66, s21
    s_waitcnt vmcnt(21)
    v_perm_b32 v200, v140, v136, s16
    s_waitcnt vmcnt(19)
    v_perm_b32 v201, v148, v144, s16
    s_waitcnt vmcnt(17)
    v_perm_b32 v202, v156, v152, s16
    s_waitcnt vmcnt(15)
    v_perm_b32 v203, v164, v160, s16
    ds_write_b128 v232, v[200:203] offset:32768
    s_add_u32 s21, s21, s64
    s_mul_i32 s21, s21, 1280
    s_mul_i32 s66, s65, 160
    s_add_u32 s21, s21, s66
    s_lshl_b32 s73, s56, 8
    s_add_u32 s73, s73, 131072
    s_add_u32 s74, s69, 40960
    buffer_load_dwordx4 a[220:223], v252, s[44:47], s74 offen sc1
    v_perm_b32 v204, v140, v136, s17
    v_perm_b32 v205, v148, v144, s17
    v_perm_b32 v206, v156, v152, s17
    v_perm_b32 v207, v164, v160, s17
    ds_write_b128 v233, v[204:207] offset:32768
    s_and_b32 s56, s56, 3
    s_mul_i32 s56, s56, 10
    s_add_u32 s69, s69, 4096
    s_sub_u32 s74, s69, 40960
    s_nop 0
    s_cselect_b32 s69, s69, s74
    buffer_load_dwordx4 a[224:227], v252, s[44:47], s69 offen sc1
    v_perm_b32 v208, v141, v137, s16
    v_perm_b32 v209, v149, v145, s16
    v_perm_b32 v210, v157, v153, s16
    v_perm_b32 v211, v165, v161, s16
    ds_write_b128 v234, v[208:211] offset:32768
    v_perm_b32 v212, v141, v137, s17
    v_perm_b32 v213, v149, v145, s17
    v_perm_b32 v214, v157, v153, s17
    v_perm_b32 v215, v165, v161, s17
    ds_write_b128 v243, v[212:215] offset:32768
    s_add_u32 s74, s69, 40960
    buffer_load_dwordx4 a[228:231], v252, s[44:47], s74 offen sc1
    v_perm_b32 v200, v142, v138, s16
    v_perm_b32 v201, v150, v146, s16
    v_perm_b32 v202, v158, v154, s16
    v_perm_b32 v203, v166, v162, s16
    ds_write_b128 v232, v[200:203] offset:33024
    s_add_u32 s69, s69, 4096
    s_sub_u32 s74, s69, 40960
    s_nop 0
    s_cselect_b32 s69, s69, s74
    buffer_load_dwordx4 a[232:235], v252, s[44:47], s69 offen sc1
    v_perm_b32 v204, v142, v138, s17
    v_perm_b32 v205, v150, v146, s17
    v_perm_b32 v206, v158, v154, s17
    v_perm_b32 v207, v166, v162, s17
    ds_write_b128 v233, v[204:207] offset:33024
    v_perm_b32 v208, v143, v139, s16
    v_perm_b32 v209, v151, v147, s16
    v_perm_b32 v210, v159, v155, s16
    v_perm_b32 v211, v167, v163, s16
    ds_write_b128 v234, v[208:211] offset:33024
    s_add_u32 s74, s69, 40960
    buffer_load_dwordx4 a[236:239], v252, s[44:47], s74 offen sc1
    v_perm_b32 v212, v143, v139, s17
    v_perm_b32 v213, v151, v147, s17
    v_perm_b32 v214, v159, v155, s17
    v_perm_b32 v215, v167, v163, s17
    ds_write_b128 v243, v[212:215] offset:33024
    s_load_dword s71, s[44:45], s18
    v_lshl_add_u32 v252, s3, 10, v4
    s_mov_b32 s74, 131072
    s_waitcnt lgkmcnt(0)
    s_mov_b32 s67, s71
    s_cmp_lt_u32 s67, 8
    s_cbranch_scc1 .Lslow_54
.Lback_55:
    s_mov_b32 s68, 2097152
    buffer_load_dwordx4 a[0:3], v247, s[44:47], s68 offen offset:0 sc1
    buffer_load_dwordx4 a[4:7], v247, s[44:47], s68 offen offset:1024 sc1
    buffer_load_dwordx4 a[8:11], v247, s[44:47], s68 offen offset:2048 sc1
    buffer_load_dwordx4 a[12:15], v247, s[44:47], s68 offen offset:3072 sc1
    buffer_load_dwordx4 a[16:19], v255, s[44:47], s68 offen offset:0 sc1
    s_mov_b32 s68, 2117632
    buffer_load_dwordx4 a[20:23], v247, s[44:47], s68 offen offset:0 sc1
    buffer_load_dwordx4 a[24:27], v247, s[44:47], s68 offen offset:1024 sc1
    buffer_load_dwordx4 a[28:31], v247, s[44:47], s68 offen offset:2048 sc1
    buffer_load_dwordx4 a[32:35], v247, s[44:47], s68 offen offset:3072 sc1
    buffer_load_dwordx4 a[36:39], v255, s[44:47], s68 offen offset:0 sc1
    s_mov_b32 s68, 2127872
    buffer_load_dwordx4 a[40:43], v247, s[44:47], s68 offen offset:0 sc1
    buffer_load_dwordx4 a[44:47], v247, s[44:47], s68 offen offset:1024 sc1
    buffer_load_dwordx4 a[48:51], v247, s[44:47], s68 offen offset:2048 sc1
    buffer_load_dwordx4 a[52:55], v247, s[44:47], s68 offen offset:3072 sc1
    buffer_load_dwordx4 a[56:59], v255, s[44:47], s68 offen offset:0 sc1
    s_mov_b32 s68, 2148352
    buffer_load_dwordx4 a[60:63], v247, s[44:47], s68 offen offset:0 sc1
    buffer_load_dwordx4 a[64:67], v247, s[44:47], s68 offen offset:1024 sc1
    buffer_load_dwordx4 a[68:71], v247, s[44:47], s68 offen offset:2048 sc1
    buffer_load_dwordx4 a[72:75], v247, s[44:47], s68 offen offset:3072 sc1
    buffer_load_dwordx4 a[76:79], v255, s[44:47], s68 offen offset:0 sc1
    s_cmp_lg_u32 s3, 1
    s_cbranch_scc1 .Lnw_56
    s_call_b64 s[48:49], .Lpad_3
.Lnw_56:
    s_cmp_lg_u32 s3, 2
    s_cbranch_scc1 .Lnw_57
    s_call_b64 s[48:49], .Lpad_4
.Lnw_57:
    s_cmp_lg_u32 s3, 3
    s_cbranch_scc1 .Lnw_58
    s_call_b64 s[48:49], .Lpad_5
.Lnw_58:
    s_waitcnt vmcnt(20)
    s_branch .Ljoin
    s_nop 7
.Lslow_2:
    s_mov_b32 s70, 100000
.Lspin_59:
    buffer_load_dword v246, off, s[40:43], 0 offset:128 sc1
    s_waitcnt vmcnt(0)
    v_readfirstlane_b32 s67, v246
    s_sub_u32 s70, s70, 1
    s_cbranch_scc1 .Ldone_60
    s_cmp_lt_u32 s67, 1
    s_cbranch_scc1 .Lspin_59
.Ldone_60:
    s_branch .Lback_3
    s_nop 7
.Lslow_5:
    s_mov_b32 s70, 100000
.Lspin_61:
    buffer_load_dword v246, off, s[40:43], 0 sc1
    s_waitcnt vmcnt(0)
    v_readfirstlane_b32 s67, v246
    s_sub_u32 s70, s70, 1
    s_cbranch_scc1 .Ldone_62
    s_cmp_lt_u32 s67, 1
    s_cbranch_scc1 .Lspin_61
.Ldone_62:
    s_branch .Lback_6
    s_nop 7
.Lslow_13:
    s_mov_b32 s70, 100000
.Lspin_63:
    buffer_load_dword v246, off, s[44:47], s63 sc1
    s_waitcnt vmcnt(0)
    v_readfirstlane_b32 s67, v246
    s_sub_u32 s70, s70, 1
    s_cbranch_scc1 .Ldone_64
    s_cmp_lt_u32 s67, 8
    s_cbranch_scc1 .Lspin_63
.Ldone_64:
    s_branch .Lback_14
    s_nop 7
.Lslow_16:
    s_mov_b32 s70, 100000
.Lspin_65:
    buffer_load_dword v244, off, s[44:47], s18 sc1
    s_waitcnt vmcnt(0)
    v_readfirstlane_b32 s67, v244
    s_sub_u32 s70, s70, 1
    s_cbranch_scc1 .Ldone_66
    s_cmp_lt_u32 s67, 8
    s_cbranch_scc1 .Lspin_65
.Ldone_66:
    s_branch .Lback_17
    s_nop 7
.Lslow_23:
    s_mov_b32 s70, 100000
.Ltop_67:
    buffer_load_dwordx2 v[216:217], v251, s[44:47], s74 offen offset:0 sc1
    buffer_load_dwordx2 v[218:219], v251, s[44:47], s74 offen offset:256 sc1
    buffer_load_dwordx2 v[220:221], v251, s[44:47], s74 offen offset:512 sc1
    buffer_load_dwordx2 v[222:223], v251, s[44:47], s74 offen offset:768 sc1
    buffer_load_dwordx2 v[224:225], v251, s[44:47], s74 offen offset:1024 sc1
    buffer_load_dwordx2 v[226:227], v251, s[44:47], s74 offen offset:1280 sc1
    buffer_load_dwordx2 v[228:229], v251, s[44:47], s74 offen offset:1536 sc1
    buffer_load_dwordx2 v[230:231], v251, s[44:47], s74 offen offset:1792 sc1
    s_nop 0
    s_waitcnt vmcnt(0)
    v_or3_b32 v250, v217, v219, v221
    v_or3_b32 v249, v223, v225, v227
    v_or3_b32 v250, v250, v229, v231
    v_or_b32 v250, v250, v249
    v_cmp_gt_i32 vcc, 0, v250
    s_sub_u32 s70, s70, 1
    s_cbranch_scc1 .Lback_24
    s_nop 3
    s_cbranch_vccnz .Ltop_67
    s_branch .Lback_24
    s_nop 7
.Lslow_25:
    s_mov_b32 s70, 100000
.Lspin_68:
    buffer_load_dword v254, off, s[44:47], s53 sc1
    s_waitcnt vmcnt(0)
    v_readfirstlane_b32 s67, v254
    s_sub_u32 s70, s70, 1
    s_cbranch_scc1 .Ldone_69
    s_cmp_lt_u32 s67, 32
    s_cbranch_scc1 .Lspin_68
.Ldone_69:
    s_branch .Lback_26
    s_nop 7
.Lslow_27:
    s_mov_b32 s70, 100000
.Lspin_70:
    buffer_load_dword v254, off, s[44:47], s53 sc1
    s_waitcnt vmcnt(0)
    v_readfirstlane_b32 s67, v254
    s_sub_u32 s70, s70, 1
    s_cbranch_scc1 .Ldone_71
    s_cmp_lt_u32 s67, 32
    s_cbranch_scc1 .Lspin_70
.Ldone_71:
    s_branch .Lback_28
    s_nop 7
.Lslow_29:
    s_mov_b32 s70, 100000
.Lspin_72:
    buffer_load_dword v254, off, s[44:47], s53 sc1
    s_waitcnt vmcnt(0)
    v_readfirstlane_b32 s67, v254
    s_sub_u32 s70, s70, 1
    s_cbranch_scc1 .Ldone_73
    s_cmp_lt_u32 s67, 32
    s_cbranch_scc1 .Lspin_72
.Ldone_73:
    s_branch .Lback_30
    s_nop 7
.Lslow_34:
    s_mov_b32 s70, 100000
.Lspin_74:
    buffer_load_dword v231, off, s[40:43], 0 offset:128 sc1
    s_waitcnt vmcnt(0)
    v_readfirstlane_b32 s67, v231
    s_sub_u32 s70, s70, 1
    s_cbranch_scc1 .Ldone_75
    s_cmp_lt_u32 s67, 1
    s_cbranch_scc1 .Lspin_74
.Ldone_75:
    s_branch .Lback_35
    s_nop 7
.Lslow_36:
    s_mov_b32 s70, 100000
.Lspin_76:
    buffer_load_dword v231, off, s[40:43], 0 sc1
    s_waitcnt vmcnt(0)
    v_readfirstlane_b32 s67, v231
    s_sub_u32 s70, s70, 1
    s_cbranch_scc1 .Ldone_77
    s_cmp_lt_u32 s67, 1
    s_cbranch_scc1 .Lspin_76
.Ldone_77:
    s_branch .Lback_37
    s_nop 7
.Lslow_40:
    s_mov_b32 s70, 100000
.Lspin_78:
    buffer_load_dword v231, off, s[40:43], 0 offset:128 sc1
    s_waitcnt vmcnt(0)
    v_readfirstlane_b32 s67, v231
    s_sub_u32 s70, s70, 1
    s_cbranch_scc1 .Ldone_79
    s_cmp_lt_u32 s67, 1
    s_cbranch_scc1 .Lspin_78
.Ldone_79:
    s_branch .Lback_41
    s_nop 7
.Lslow_42:
    s_mov_b32 s70, 100000
.Lspin_80:
    buffer_load_dword v231, off, s[40:43], 0 sc1
    s_waitcnt vmcnt(0)
    v_readfirstlane_b32 s67, v231
    s_sub_u32 s70, s70, 1
    s_cbranch_scc1 .Ldone_81
    s_cmp_lt_u32 s67, 1
    s_cbranch_scc1 .Lspin_80
.Ldone_81:
    s_branch .Lback_43
    s_nop 7
.Lslow_52:
    s_mov_b32 s70, 100000
.Lspin_82:
    buffer_load_dword v1, off, s[44:47], s64 sc1
    s_waitcnt vmcnt(0)
    v_readfirstlane_b32 s67, v1
    s_sub_u32 s70, s70, 1
    s_cbranch_scc1 .Ldone_83
    s_cmp_lt_u32 s67, 8
    s_cbranch_scc1 .Lspin_82
.Ldone_83:
    s_branch .Lback_53
    s_nop 7
.Lslow_54:
    s_mov_b32 s70, 100000
.Lspin_84:
    buffer_load_dword v244, off, s[44:47], s18 sc1
    s_waitcnt vmcnt(0)
    v_readfirstlane_b32 s67, v244
    s_sub_u32 s70, s70, 1
    s_cbranch_scc1 .Ldone_85
    s_cmp_lt_u32 s67, 8
    s_cbranch_scc1 .Lspin_84
.Ldone_85:
    s_branch .Lback_55
.Lcode_end:
    s_endpgm
.Lpad_6:
.Lpad_7:
    s_setpc_b64 s[48:49]
.p2align 12
    s_endpgm
.section .rodata,"a"
.p2align 6
.amdhsa_kernel sequential_preLN__ssm_conv_h3__geglu_ffn__prompt_kernel
  .amdhsa_next_free_vgpr 512
  .amdhsa_next_free_sgpr 102
  .amdhsa_accum_offset 256
  .amdhsa_group_segment_fixed_size 0
  .amdhsa_kernarg_size 104
  .amdhsa_user_sgpr_count 2
  .amdhsa_user_sgpr_kernarg_segment_ptr 1
  .amdhsa_system_sgpr_workgroup_id_x 1
  .amdhsa_float_denorm_mode_32 3
.end_amdhsa_kernel
```
